```python
import torch

def _softmax(x, axis=-1):
    return torch.softmax(x, dim=axis)
def _gelu(x):
    return torch.nn.functional.gelu(x, approximate="tanh")
def _silu(x):
    return torch.nn.functional.silu(x)
def _sigmoid(x):
    return torch.sigmoid(x)
def _layernorm(x, axis=-1, eps=1e-5):
    m = x.mean(dim=axis, keepdim=True)
    v = x.var(dim=axis, keepdim=True, unbiased=False)
    return (x - m) / torch.sqrt(v + eps)
def _scatter_add(tgt, idx, src, axis=0):
    return tgt.clone().index_add_(axis, idx, src)
def _segment_sum(src, seg, n):
    out = torch.zeros((n,) + src.shape[1:], dtype=src.dtype)
    return out.index_add_(0, seg, src)
def _pad(x, pw):
    flat = tuple(v for pair in reversed(pw) for v in pair)
    return torch.nn.functional.pad(x, flat)

kernel_name = 'gated_mix__sliding_local_dilated__swiglu_ffn__prompt'

def setup_inputs():

    _w = (lambda a: (lambda t: t.to(torch.bfloat16) if t.is_floating_point() else t)(torch.as_tensor(a)))
    def _A_setup():
        B, S, D = 1, 2048, 640
        return {
            "x": _w((lambda *s: torch.randn(*s, dtype=torch.bfloat16) * 0.05)(B, S, D)),
            "wqkv": _w((lambda *s: torch.randn(*s, dtype=torch.bfloat16) * 0.8)(D, 3 * D)),
            "wo": _w((lambda *s: torch.randn(*s, dtype=torch.bfloat16) * 0.05)(D, D)),
        }
    _A_in = _A_setup()

    def _B_setup():
        B, S, D, F = 1, 2048, 640, 1536
        return {
            "x": _w((lambda *s: torch.randn(*s, dtype=torch.bfloat16) * 0.05)(B, S, D)),
            "w_gate": _w((lambda *s: torch.randn(*s, dtype=torch.bfloat16) * 0.2)(D, F)),
            "w_up": _w((lambda *s: torch.randn(*s, dtype=torch.bfloat16) * 0.2)(D, F)),
            "w_down": _w((lambda *s: torch.randn(*s, dtype=torch.bfloat16) * 0.2)(F, D)),
        }
    _B_in = _B_setup()

    return {
        "A_x": _A_in["x"],
        "A_wqkv": _A_in["wqkv"],
        "A_wo": _A_in["wo"],
        "B_x": _B_in["x"],
        "B_w_gate": _B_in["w_gate"],
        "B_w_up": _B_in["w_up"],
        "B_w_down": _B_in["w_down"],
        "gate_w": _w((lambda *s: torch.randn(*s, dtype=torch.bfloat16) * 0.05)(640) * 16.0),
    }

def reference(A_x, A_wqkv, A_wo, B_x, B_w_gate, B_w_up, B_w_down, gate_w):
    def _A_ref(x, wqkv, wo):
        B, S, D = x.shape
        H = 32; Dh = D // H
        W, dil = 8, 2
        qkv = (lambda x, *d: x.permute(*d))((x @ wqkv).reshape(B, S, 3, H, Dh), 2, 0, 3, 1, 4)
        q, k, v = qkv[0], qkv[1], qkv[2]
        scale = Dh ** -0.5
        pos = torch.arange(S)
        off = torch.arange(W) * dil
        idx = pos[:, None] - off[None, :]
        mask = idx >= 0
        idx_c = torch.where(mask, idx, 0).reshape(-1)
        kg = k[:, :, idx_c, :].reshape(B, H, S, W, Dh)
        vg = v[:, :, idx_c, :].reshape(B, H, S, W, Dh)
        logits = torch.einsum("bhsd,bhswd->bhsw", q, kg) * scale
        logits = torch.where(mask[None, None, :, :], logits, -1e9)
        attn = _softmax(logits, axis=-1)
        o = torch.einsum("bhsw,bhswd->bhsd", attn, vg)
        return (lambda x, *d: x.permute(*d))(o, 0, 2, 1, 3).reshape(B, S, D) @ wo

    def _B_ref(x, w_gate, w_up, w_down):
        g = _silu(x @ w_gate)
        u = x @ w_up
        return (g * u) @ w_down

    x = A_x
    g = _sigmoid((x * gate_w).sum(-1, keepdims=True))
    a = _A_ref(x, A_wqkv, A_wo)
    b = _B_ref(x, B_w_gate, B_w_up, B_w_down)
    return g * a + (1 - g) * b
```

```asm
; @launch grid=(256,1,1) block=(512,1,1) lds=163840
.amdgcn_target "amdgcn-amd-amdhsa--gfx950"
.text
.globl gated_mix__sliding_local_dilated__swiglu_ffn__prompt_kernel
.p2align 8
.type gated_mix__sliding_local_dilated__swiglu_ffn__prompt_kernel,@function
gated_mix__sliding_local_dilated__swiglu_ffn__prompt_kernel:
    s_cmp_ge_u32 s2, 256
    s_cbranch_scc1 K_END
    s_load_dwordx16 s[4:19], s[0:1], 0
    s_load_dwordx4 s[72:75], s[0:1], 64
    s_load_dwordx2 s[20:21], s[0:1], 80
    s_memrealtime s[70:71]
    v_lshrrev_b32 v1, 6, v0
    v_and_b32 v0, 63, v0
    v_readfirstlane_b32 s46, v1
    s_and_b32 s54, s2, 7
    s_lshr_b32 s55, s2, 3
    s_and_b32 s44, s55, 7
    s_and_b32 s56, s54, 1
    s_lshl_b32 s56, s56, 3
    s_add_u32 s44, s44, s56
    s_lshr_b32 s55, s55, 3
    s_and_b32 s45, s54, 6
    s_and_b32 s56, s55, 1
    s_add_u32 s45, s45, s56
    s_mov_b32 s3, 0
    s_lshr_b32 s56, s2, 1
    s_xor_b32 s56, s56, s2
    s_bitcmp1_b32 s56, 0
    s_mov_b32 s68, 0x76543210
    s_cselect_b32 s68, 0x21098765, s68
    s_mov_b32 s69, 0x98
    s_cselect_b32 s69, 0x43, s69
    s_sub_u32 s56, s55, s44
    s_and_b32 s56, s56, 3
    s_lshl_b32 s56, s56, 2
    s_mov_b32 s64, 0x000f000f
    s_mov_b32 s65, 0xf
    s_lshl_b64 s[64:65], s[64:65], s56
    s_and_b32 s65, s65, 0xf
    s_and_b64 s[66:67], s[68:69], s[64:65]
    s_lshl_b64 s[66:67], s[66:67], 4
    s_lshr_b64 s[62:63], s[68:69], 4
    s_and_b64 s[62:63], s[62:63], s[64:65]
    s_or_b64 s[66:67], s[66:67], s[62:63]
    s_lshl_b64 s[62:63], s[64:65], 4
    s_or_b64 s[64:65], s[64:65], s[62:63]
    s_andn2_b64 s[68:69], s[68:69], s[64:65]
    s_or_b64 s[68:69], s[68:69], s[66:67]
    v_lshrrev_b32 v3, 3, v0
    v_mul_u32_u24 v2, 2560, v3
    v_lshrrev_b32 v3, 4, v0
    s_lshl_b32 s56, s46, 2
    v_add_u32 v3, s56, v3
    v_xor_b32 v3, v3, v0
    v_and_b32 v3, 7, v3
    v_lshl_add_u32 v2, v3, 4, v2
    s_lshl_b32 s56, s44, 3
    s_and_b32 s57, s46, 3
    s_add_u32 s56, s56, s57
    s_lshl_b32 s56, s56, 4
    s_lshr_b32 s57, s46, 2
    s_add_u32 s56, s56, s57
    s_mul_i32 s56, s56, 1280
    v_add_u32 v2, s56, v2
    v_lshrrev_b32 v3, 5, v0
    v_and_b32 v1, 31, v0
    s_cmp_ge_u32 s55, 2
    s_cbranch_scc1 K_QKV
    s_and_b32 s54, s46, 3
    s_lshr_b32 s55, s46, 2
    s_mul_i32 s56, s54, 24576
    s_mul_i32 s57, s45, 384
    s_add_u32 s56, s56, s57
    s_lshl_b32 s57, s55, 2
    s_and_b32 s57, s46, 1
    s_lshl_b32 s57, s57, 2
    v_add_u32 v14, 0, v0
    v_mul_u32_u24 v15, 2731, v14
    v_lshrrev_b32 v15, 16, v15
    v_mul_u32_u24 v7, 24, v15
    v_sub_u32 v14, v14, v7
    v_and_b32 v7, 2, v15
    v_xor_b32 v14, v14, v7
    v_xor_b32 v14, s57, v14
    v_mul_u32_u24 v15, 3072, v15
    v_lshl_add_u32 v14, v14, 4, v15
    v_add_u32 v4, s56, v14
    s_sub_u32 s56, s56, 1024
    v_add_u32 v14, 64, v0
    v_mul_u32_u24 v15, 2731, v14
    v_lshrrev_b32 v15, 16, v15
    v_mul_u32_u24 v7, 24, v15
    v_sub_u32 v14, v14, v7
    v_and_b32 v7, 2, v15
    v_xor_b32 v14, v14, v7
    v_xor_b32 v14, s57, v14
    v_mul_u32_u24 v15, 3072, v15
    v_lshl_add_u32 v14, v14, 4, v15
    v_add_u32 v5, s56, v14
    s_sub_u32 s56, s56, 1024
    v_add_u32 v14, 128, v0
    v_mul_u32_u24 v15, 2731, v14
    v_lshrrev_b32 v15, 16, v15
    v_mul_u32_u24 v7, 24, v15
    v_sub_u32 v14, v14, v7
    v_and_b32 v7, 2, v15
    v_xor_b32 v14, v14, v7
    v_xor_b32 v14, s57, v14
    v_mul_u32_u24 v15, 3072, v15
    v_lshl_add_u32 v14, v14, 4, v15
    v_add_u32 v6, s56, v14
    s_sub_u32 s56, s56, 1024
    s_mul_i32 s48, s55, 12288
    s_mul_i32 s56, s54, 3072
    s_add_u32 s48, s48, s56
    s_lshl_b32 s58, s46, 10
    s_add_u32 s58, s58, 98304
    s_waitcnt lgkmcnt(0)
    s_cmp_eq_u32 s55, 0
    s_cselect_b32 s22, s12, s14
    s_cselect_b32 s23, s13, s15
    s_mov_b32 s24, s4
    s_and_b32 s25, s5, 0xffff
    s_mov_b32 s26, 2621440
    s_mov_b32 s27, 0x00020000
    s_mov_b32 s28, s22
    s_and_b32 s29, s23, 0xffff
    s_mov_b32 s30, 1966080
    s_mov_b32 s31, 0x00020000
    s_mov_b32 s64, s74
    s_and_b32 s65, s75, 0xffff
    s_mov_b32 s66, 256
    s_mov_b32 s67, 0x00020000
    s_cmp_ge_u32 s2, 8
    s_cbranch_scc1 NP130
    s_cmp_lg_u32 s46, 3
    s_cbranch_scc1 NP130
    s_or_b32 s56, s70, 1
    v_mov_b32 v156, s56
    v_mov_b32 v157, 0
    s_mov_b64 exec, 1
    buffer_atomic_cmpswap v[156:157], off, s[64:67], 0 sc1
    s_mov_b64 exec, -1
NP130:
    v_mov_b32 v154, s68
    v_mov_b32 v155, s69
    s_and_b32 s51, s68, 15
    s_lshl_b32 s51, s51, 7
    s_lshr_b64 s[68:69], s[68:69], 4
    s_mul_i32 s49, s51, 1536
    s_add_u32 m0, s58, 0
    s_add_u32 s56, s51, 0
    buffer_load_dwordx4 v2, s[24:27], s56 offen lds
    s_add_u32 m0, s58, 8192
    s_add_u32 s56, s51, 81920
    buffer_load_dwordx4 v2, s[24:27], s56 offen lds
    s_add_u32 m0, s48, 0
    s_add_u32 s57, s49, 0
    buffer_load_dwordx4 v4, s[28:31], s57 offen offset:0 lds
    buffer_load_dwordx4 v5, s[28:31], s57 offen offset:1024 lds
    buffer_load_dwordx4 v6, s[28:31], s57 offen offset:2048 lds
    s_barrier
    s_mov_b32 s32, s20
    s_and_b32 s33, s21, 0xffff
    s_mov_b32 s34, 12607488
    s_mov_b32 s35, 0x00020000
    s_lshr_b32 s56, s2, 3
    s_and_b32 s56, s56, 15
    s_cmp_lg_u32 s56, 0
    s_cbranch_scc1 CT163
    s_cmp_ge_u32 s46, 3
    s_cbranch_scc1 CT163
    s_getpc_b64 s[56:57]
CT163p:
    s_sub_u32 s56, s56, CT163p-gated_mix__sliding_local_dilated__swiglu_ffn__prompt_kernel
    s_subb_u32 s57, s57, 0
    v_lshlrev_b32 v158, 7, v0
    s_lshl_b32 s10, s46, 13
    v_add_u32 v158, s10, v158
    v_min_u32 v158, K_END-gated_mix__sliding_local_dilated__swiglu_ffn__prompt_kernel, v158
    global_load_dword v158, v158, s[56:57]
CT163:
    v_and_b32 v14, 15, v0
    v_lshrrev_b32 v7, 4, v0
    v_lshrrev_b32 v15, 1, v14
    v_xor_b32 v15, v15, v7
    v_lshlrev_b32 v15, 4, v15
    v_lshl_add_u32 v11, v14, 7, v15
    s_lshl_b32 s56, s55, 13
    s_add_u32 s56, s56, 98304
    v_add_u32 v11, s56, v11
    v_mov_b32 v12, v11
    v_bfe_u32 v14, v0, 4, 1
    v_bfe_u32 v15, v0, 2, 2
    v_lshl_add_u32 v7, v7, 3, v15
    v_mul_u32_u24 v7, 384, v7
    v_and_b32 v13, 3, v0
    v_lshl_add_u32 v7, v13, 3, v7
    v_lshrrev_b32 v15, 1, v15
    v_lshl_or_b32 v14, v14, 1, v15
    s_mul_i32 s56, s54, 3
    v_xor_b32 v15, s56, v14
    v_lshl_add_u32 v8, v15, 5, v7
    s_add_u32 s56, s56, 1
    v_xor_b32 v15, s56, v14
    v_lshl_add_u32 v9, v15, 5, v7
    s_add_u32 s56, s56, 1
    v_xor_b32 v15, s56, v14
    v_lshl_add_u32 v10, v15, 5, v7
    s_add_u32 s56, s56, 1
    s_lshl_b32 s56, s44, 1
    s_add_u32 s56, s56, s55
    s_mul_i32 s56, s56, 278528
    s_mul_i32 s57, s45, 12288
    s_add_u32 s56, s56, s57
    s_mul_i32 s57, s54, 3072
    s_add_u32 s56, s56, s57
    s_add_u32 s36, s56, 40960
    s_add_u32 s37, s36, 139264
    s_mov_b32 s62, 3216550459
    s_mov_b32 s63, 3216550459
    s_lshl_b32 s61, s44, 5
    s_add_u32 s61, s61, s45
    s_and_b32 s54, s2, 7
    s_lshr_b32 s55, s2, 3
    s_lshl_b32 s22, s54, 2
    s_and_b32 s56, s55, 3
    s_add_u32 s22, s22, s56
    s_lshr_b32 s23, s55, 2
    s_and_b32 s22, s54, 3
    s_lshl_b32 s22, s22, 3
    s_and_b32 s56, s55, 7
    s_add_u32 s22, s22, s56
    s_and_b32 s23, s54, 4
    s_lshr_b32 s56, s55, 3
    s_add_u32 s23, s23, s56
    s_lshl_b32 s54, s46, 3
    s_add_u32 s54, s54, 4
    s_mul_i32 s55, s46, 9
    s_cmp_lt_u32 s46, 4
    s_cselect_b32 s54, s55, s54
    s_mul_i32 s56, s23, 68
    s_add_u32 s56, s56, s54
    s_mul_i32 s56, s56, 5120
    s_add_u32 s77, s56, 9437184
    s_mul_i32 s56, s22, 278528
    s_lshl_b32 s54, s54, 11
    s_add_u32 s80, s56, s54
    s_mov_b32 s78, 0x76543210
    s_mov_b32 s79, 8
    v_lshlrev_b32 v152, 4, v0
    v_add_u32 v153, 4096, v152
    s_mov_b32 s81, s78
    s_mov_b32 s76, s77
    s_cmp_eq_u32 s46, 3
    s_cselect_b32 s60, 192, 0
    s_mov_b32 s50, 32768
    s_mov_b32 s52, 0
    s_mov_b32 s53, 49152
    s_add_u32 m0, s48, 24576
    s_add_u32 s57, s49, 98304
    buffer_load_dwordx4 v4, s[28:31], s57 offen offset:0 lds
    buffer_load_dwordx4 v5, s[28:31], s57 offen offset:1024 lds
    buffer_load_dwordx4 v6, s[28:31], s57 offen offset:2048 lds
    s_and_b32 s51, s68, 15
    s_lshl_b32 s51, s51, 7
    s_lshr_b64 s[68:69], s[68:69], 4
    s_mul_i32 s49, s51, 1536
    s_waitcnt vmcnt(3)
    s_barrier
    ds_read_b64_tr_b16 v[32:33], v8 offset:0
    ds_read_b64_tr_b16 v[34:35], v8 offset:1536
    ds_read_b64_tr_b16 v[36:37], v8 offset:12288
    ds_read_b128 v[16:19], v12 offset:0
    ds_read_b64_tr_b16 v[38:39], v8 offset:13824
    ds_read_b64_tr_b16 v[40:41], v9 offset:0
    ds_read_b128 v[20:23], v12 offset:2048
    ds_read_b64_tr_b16 v[42:43], v9 offset:1536
    ds_read_b128 v[24:27], v12 offset:4096
    s_waitcnt lgkmcnt(1)
    v_mfma_f32_16x16x32_bf16 v[56:59], v[32:35], v[16:19], 0
    ds_read_b128 v[28:31], v12 offset:6144
    s_add_u32 m0, s58, 16384
    v_mfma_f32_16x16x32_bf16 v[72:75], v[36:39], v[16:19], 0
    ds_read_b64_tr_b16 v[44:45], v9 offset:12288
    s_add_u32 s56, s51, 0
    v_mfma_f32_16x16x32_bf16 v[88:91], v[40:43], v[16:19], 0
    ds_read_b64_tr_b16 v[46:47], v9 offset:13824
    buffer_load_dwordx4 v2, s[24:27], s56 offen lds
    s_add_u32 m0, s48, 49152
    v_mfma_f32_16x16x32_bf16 v[60:63], v[32:35], v[20:23], 0
    ds_read_b64_tr_b16 v[48:49], v10 offset:0
    s_add_u32 s57, s49, 0
    v_mfma_f32_16x16x32_bf16 v[76:79], v[36:39], v[20:23], 0
    ds_read_b64_tr_b16 v[50:51], v10 offset:1536
    buffer_load_dwordx4 v4, s[28:31], s57 offen offset:0 lds
    v_mfma_f32_16x16x32_bf16 v[92:95], v[40:43], v[20:23], 0
    ds_read_b64_tr_b16 v[52:53], v10 offset:12288
    s_setprio 0
    s_waitcnt lgkmcnt(6)
    v_mfma_f32_16x16x32_bf16 v[64:67], v[32:35], v[24:27], 0
    ds_read_b64_tr_b16 v[54:55], v10 offset:13824
    buffer_load_dwordx4 v5, s[28:31], s57 offen offset:1024 lds
    v_mfma_f32_16x16x32_bf16 v[80:83], v[36:39], v[24:27], 0
    buffer_load_dwordx4 v6, s[28:31], s57 offen offset:2048 lds
    s_add_u32 m0, s58, 24576
    v_mfma_f32_16x16x32_bf16 v[96:99], v[40:43], v[24:27], 0
    s_add_u32 s56, s51, 81920
    buffer_load_dwordx4 v2, s[24:27], s56 offen lds
    s_add_u32 s49, s49, 98304
    s_waitcnt lgkmcnt(6)
    v_mfma_f32_16x16x32_bf16 v[68:71], v[32:35], v[28:31], 0
    s_and_b32 s51, s68, 15
    s_lshl_b32 s51, s51, 7
    v_mfma_f32_16x16x32_bf16 v[84:87], v[36:39], v[28:31], 0
    s_lshr_b64 s[68:69], s[68:69], 4
    v_xor_b32 v13, 64, v12
    v_mfma_f32_16x16x32_bf16 v[100:103], v[40:43], v[28:31], 0
    s_setprio 3
    s_waitcnt vmcnt(5) lgkmcnt(0)
    s_barrier
    v_mfma_f32_16x16x32_bf16 v[104:107], v[44:47], v[16:19], 0
    ds_read_b64_tr_b16 v[32:33], v8 offset:24576
    s_add_u32 s54, s48, s53
    v_mfma_f32_16x16x32_bf16 v[120:123], v[48:51], v[16:19], 0
    ds_read_b64_tr_b16 v[34:35], v8 offset:26112
    v_mfma_f32_16x16x32_bf16 v[136:139], v[52:55], v[16:19], 0
    ds_read_b64_tr_b16 v[36:37], v8 offset:36864
    s_add_u32 m0, s54, 24576
    v_mfma_f32_16x16x32_bf16 v[108:111], v[44:47], v[20:23], 0
    ds_read_b128 v[16:19], v13 offset:0
    buffer_load_dwordx4 v4, s[28:31], s49 offen offset:0 lds
    v_mfma_f32_16x16x32_bf16 v[124:127], v[48:51], v[20:23], 0
    ds_read_b64_tr_b16 v[38:39], v8 offset:38400
    v_mfma_f32_16x16x32_bf16 v[140:143], v[52:55], v[20:23], 0
    ds_read_b64_tr_b16 v[40:41], v9 offset:24576
    s_setprio 2
    v_mfma_f32_16x16x32_bf16 v[112:115], v[44:47], v[24:27], 0
    ds_read_b128 v[20:23], v13 offset:2048
    buffer_load_dwordx4 v5, s[28:31], s49 offen offset:1024 lds
    v_mfma_f32_16x16x32_bf16 v[128:131], v[48:51], v[24:27], 0
    ds_read_b64_tr_b16 v[42:43], v9 offset:26112
    v_mfma_f32_16x16x32_bf16 v[144:147], v[52:55], v[24:27], 0
    buffer_load_dwordx4 v6, s[28:31], s49 offen offset:2048 lds
    s_mul_i32 s49, s51, 1536
    v_mfma_f32_16x16x32_bf16 v[116:119], v[44:47], v[28:31], 0
    ds_read_b128 v[24:27], v13 offset:4096
    s_add_u32 m0, s58, s50
    v_mfma_f32_16x16x32_bf16 v[132:135], v[48:51], v[28:31], 0
    s_add_u32 s56, s51, 81920
    v_mfma_f32_16x16x32_bf16 v[148:151], v[52:55], v[28:31], 0
    s_setprio 1
    buffer_load_dwordx4 v2, s[24:27], s51 offen lds
    s_waitcnt lgkmcnt(1)
    v_mfma_f32_16x16x32_bf16 v[56:59], v[32:35], v[16:19], v[56:59]
    ds_read_b128 v[28:31], v13 offset:6144
    s_mov_b32 m0, s48
    v_mfma_f32_16x16x32_bf16 v[72:75], v[36:39], v[16:19], v[72:75]
    ds_read_b64_tr_b16 v[44:45], v9 offset:36864
    v_mfma_f32_16x16x32_bf16 v[88:91], v[40:43], v[16:19], v[88:91]
    ds_read_b64_tr_b16 v[46:47], v9 offset:38400
    s_add_u32 s55, s58, s50
    v_mfma_f32_16x16x32_bf16 v[60:63], v[32:35], v[20:23], v[60:63]
    ds_read_b64_tr_b16 v[48:49], v10 offset:24576
    buffer_load_dwordx4 v4, s[28:31], s49 offen offset:0 lds
    v_mfma_f32_16x16x32_bf16 v[76:79], v[36:39], v[20:23], v[76:79]
    ds_read_b64_tr_b16 v[50:51], v10 offset:26112
    buffer_load_dwordx4 v5, s[28:31], s49 offen offset:1024 lds
    v_mfma_f32_16x16x32_bf16 v[92:95], v[40:43], v[20:23], v[92:95]
    ds_read_b64_tr_b16 v[52:53], v10 offset:36864
    s_setprio 0
    s_waitcnt lgkmcnt(6)
    v_mfma_f32_16x16x32_bf16 v[64:67], v[32:35], v[24:27], v[64:67]
    ds_read_b64_tr_b16 v[54:55], v10 offset:38400
    v_mfma_f32_16x16x32_bf16 v[80:83], v[36:39], v[24:27], v[80:83]
    s_add_u32 s52, s52, 16384
    s_cmp_eq_u32 s52, 49152
    v_mfma_f32_16x16x32_bf16 v[96:99], v[40:43], v[24:27], v[96:99]
    s_cselect_b32 s52, 0, s52
    v_add_u32 v12, s52, v11
    s_waitcnt lgkmcnt(6)
    v_mfma_f32_16x16x32_bf16 v[68:71], v[32:35], v[28:31], v[68:71]
    v_add_u32 v8, s53, v8
    v_mfma_f32_16x16x32_bf16 v[84:87], v[36:39], v[28:31], v[84:87]
    v_add_u32 v9, s53, v9
    v_add_u32 v10, s53, v10
    v_mfma_f32_16x16x32_bf16 v[100:103], v[40:43], v[28:31], v[100:103]
    s_setprio 3
    s_waitcnt vmcnt(6) lgkmcnt(0)
    s_barrier
    v_mfma_f32_16x16x32_bf16 v[104:107], v[44:47], v[16:19], v[104:107]
    ds_read_b64_tr_b16 v[32:33], v8 offset:0
    buffer_load_dwordx4 v6, s[28:31], s49 offen offset:2048 lds
    v_mfma_f32_16x16x32_bf16 v[120:123], v[48:51], v[16:19], v[120:123]
    ds_read_b64_tr_b16 v[34:35], v8 offset:1536
    s_add_u32 s49, s49, 98304
    v_mfma_f32_16x16x32_bf16 v[136:139], v[52:55], v[16:19], v[136:139]
    ds_read_b64_tr_b16 v[36:37], v8 offset:12288
    s_add_u32 m0, s55, 8192
    v_mfma_f32_16x16x32_bf16 v[108:111], v[44:47], v[20:23], v[108:111]
    ds_read_b128 v[16:19], v12 offset:0
    buffer_load_dwordx4 v2, s[24:27], s56 offen lds
    v_mfma_f32_16x16x32_bf16 v[124:127], v[48:51], v[20:23], v[124:127]
    ds_read_b64_tr_b16 v[38:39], v8 offset:13824
    s_and_b32 s51, s68, 15
    v_mfma_f32_16x16x32_bf16 v[140:143], v[52:55], v[20:23], v[140:143]
    ds_read_b64_tr_b16 v[40:41], v9 offset:0
    s_setprio 2
    v_mfma_f32_16x16x32_bf16 v[112:115], v[44:47], v[24:27], v[112:115]
    ds_read_b128 v[20:23], v12 offset:2048
    s_lshl_b32 s51, s51, 7
    v_mfma_f32_16x16x32_bf16 v[128:131], v[48:51], v[24:27], v[128:131]
    ds_read_b64_tr_b16 v[42:43], v9 offset:1536
    s_lshr_b64 s[68:69], s[68:69], 4
    v_mfma_f32_16x16x32_bf16 v[144:147], v[52:55], v[24:27], v[144:147]
    s_add_u32 s50, s50, 16384
    s_cmp_eq_u32 s50, 49152
    v_mfma_f32_16x16x32_bf16 v[116:119], v[44:47], v[28:31], v[116:119]
    ds_read_b128 v[24:27], v12 offset:4096
    s_cselect_b32 s50, 0, s50
    v_mfma_f32_16x16x32_bf16 v[132:135], v[48:51], v[28:31], v[132:135]
    s_add_u32 s48, s48, s53
    s_sub_u32 s53, 0, s53
    v_mfma_f32_16x16x32_bf16 v[148:151], v[52:55], v[28:31], v[148:151]
    s_setprio 1
    s_mov_b32 s47, 1
    s_branch F_CHK
F_LOOP:
    s_waitcnt lgkmcnt(1)
    v_mfma_f32_16x16x32_bf16 v[56:59], v[32:35], v[16:19], v[56:59]
    ds_read_b128 v[28:31], v12 offset:6144
    v_mfma_f32_16x16x32_bf16 v[72:75], v[36:39], v[16:19], v[72:75]
    ds_read_b64_tr_b16 v[44:45], v9 offset:12288
    v_mfma_f32_16x16x32_bf16 v[88:91], v[40:43], v[16:19], v[88:91]
    ds_read_b64_tr_b16 v[46:47], v9 offset:13824
    s_add_u32 s54, s48, s53
    v_mfma_f32_16x16x32_bf16 v[60:63], v[32:35], v[20:23], v[60:63]
    ds_read_b64_tr_b16 v[48:49], v10 offset:0
    v_mfma_f32_16x16x32_bf16 v[76:79], v[36:39], v[20:23], v[76:79]
    ds_read_b64_tr_b16 v[50:51], v10 offset:1536
    v_mfma_f32_16x16x32_bf16 v[92:95], v[40:43], v[20:23], v[92:95]
    ds_read_b64_tr_b16 v[52:53], v10 offset:12288
    s_setprio 0
    s_waitcnt lgkmcnt(6)
    v_mfma_f32_16x16x32_bf16 v[64:67], v[32:35], v[24:27], v[64:67]
    ds_read_b64_tr_b16 v[54:55], v10 offset:13824
    v_mfma_f32_16x16x32_bf16 v[80:83], v[36:39], v[24:27], v[80:83]
    v_mfma_f32_16x16x32_bf16 v[96:99], v[40:43], v[24:27], v[96:99]
    s_add_u32 m0, s54, 24576
    s_nop 0
    buffer_load_dwordx4 v4, s[28:31], s49 offen offset:0 lds
    s_waitcnt lgkmcnt(6)
    v_mfma_f32_16x16x32_bf16 v[68:71], v[32:35], v[28:31], v[68:71]
    buffer_load_dwordx4 v5, s[28:31], s49 offen offset:1024 lds
    v_mfma_f32_16x16x32_bf16 v[84:87], v[36:39], v[28:31], v[84:87]
    v_xor_b32 v13, 64, v12
    v_mfma_f32_16x16x32_bf16 v[100:103], v[40:43], v[28:31], v[100:103]
    s_setprio 3
    s_waitcnt vmcnt(6) lgkmcnt(0)
    s_barrier
    v_mfma_f32_16x16x32_bf16 v[104:107], v[44:47], v[16:19], v[104:107]
    ds_read_b64_tr_b16 v[32:33], v8 offset:24576
    v_mfma_f32_16x16x32_bf16 v[120:123], v[48:51], v[16:19], v[120:123]
    ds_read_b64_tr_b16 v[34:35], v8 offset:26112
    buffer_load_dwordx4 v6, s[28:31], s49 offen offset:2048 lds
    v_mfma_f32_16x16x32_bf16 v[136:139], v[52:55], v[16:19], v[136:139]
    ds_read_b64_tr_b16 v[36:37], v8 offset:36864
    v_mfma_f32_16x16x32_bf16 v[108:111], v[44:47], v[20:23], v[108:111]
    ds_read_b128 v[16:19], v13 offset:0
    v_mfma_f32_16x16x32_bf16 v[124:127], v[48:51], v[20:23], v[124:127]
    ds_read_b64_tr_b16 v[38:39], v8 offset:38400
    s_mul_i32 s49, s51, 1536
    v_mfma_f32_16x16x32_bf16 v[140:143], v[52:55], v[20:23], v[140:143]
    ds_read_b64_tr_b16 v[40:41], v9 offset:24576
    s_setprio 2
    v_mfma_f32_16x16x32_bf16 v[112:115], v[44:47], v[24:27], v[112:115]
    ds_read_b128 v[20:23], v13 offset:2048
    v_mfma_f32_16x16x32_bf16 v[128:131], v[48:51], v[24:27], v[128:131]
    ds_read_b64_tr_b16 v[42:43], v9 offset:26112
    v_mfma_f32_16x16x32_bf16 v[144:147], v[52:55], v[24:27], v[144:147]
    s_add_u32 m0, s58, s50
    v_mfma_f32_16x16x32_bf16 v[116:119], v[44:47], v[28:31], v[116:119]
    ds_read_b128 v[24:27], v13 offset:4096
    v_mfma_f32_16x16x32_bf16 v[132:135], v[48:51], v[28:31], v[132:135]
    s_add_u32 s56, s51, 81920
    buffer_load_dwordx4 v2, s[24:27], s51 offen lds
    v_mfma_f32_16x16x32_bf16 v[148:151], v[52:55], v[28:31], v[148:151]
    s_setprio 1
    s_waitcnt lgkmcnt(1)
    v_mfma_f32_16x16x32_bf16 v[56:59], v[32:35], v[16:19], v[56:59]
    ds_read_b128 v[28:31], v13 offset:6144
    s_mov_b32 m0, s48
    v_mfma_f32_16x16x32_bf16 v[72:75], v[36:39], v[16:19], v[72:75]
    ds_read_b64_tr_b16 v[44:45], v9 offset:36864
    v_mfma_f32_16x16x32_bf16 v[88:91], v[40:43], v[16:19], v[88:91]
    ds_read_b64_tr_b16 v[46:47], v9 offset:38400
    s_add_u32 s55, s58, s50
    v_mfma_f32_16x16x32_bf16 v[60:63], v[32:35], v[20:23], v[60:63]
    ds_read_b64_tr_b16 v[48:49], v10 offset:24576
    buffer_load_dwordx4 v4, s[28:31], s49 offen offset:0 lds
    v_mfma_f32_16x16x32_bf16 v[76:79], v[36:39], v[20:23], v[76:79]
    ds_read_b64_tr_b16 v[50:51], v10 offset:26112
    buffer_load_dwordx4 v5, s[28:31], s49 offen offset:1024 lds
    v_mfma_f32_16x16x32_bf16 v[92:95], v[40:43], v[20:23], v[92:95]
    ds_read_b64_tr_b16 v[52:53], v10 offset:36864
    s_setprio 0
    s_waitcnt lgkmcnt(6)
    v_mfma_f32_16x16x32_bf16 v[64:67], v[32:35], v[24:27], v[64:67]
    ds_read_b64_tr_b16 v[54:55], v10 offset:38400
    v_mfma_f32_16x16x32_bf16 v[80:83], v[36:39], v[24:27], v[80:83]
    s_add_u32 s52, s52, 16384
    s_cmp_eq_u32 s52, 49152
    v_mfma_f32_16x16x32_bf16 v[96:99], v[40:43], v[24:27], v[96:99]
    s_cselect_b32 s52, 0, s52
    v_add_u32 v12, s52, v11
    s_waitcnt lgkmcnt(6)
    v_mfma_f32_16x16x32_bf16 v[68:71], v[32:35], v[28:31], v[68:71]
    v_add_u32 v8, s53, v8
    v_mfma_f32_16x16x32_bf16 v[84:87], v[36:39], v[28:31], v[84:87]
    v_add_u32 v9, s53, v9
    v_add_u32 v10, s53, v10
    v_mfma_f32_16x16x32_bf16 v[100:103], v[40:43], v[28:31], v[100:103]
    s_setprio 3
    s_waitcnt vmcnt(6) lgkmcnt(0)
    s_barrier
    v_mfma_f32_16x16x32_bf16 v[104:107], v[44:47], v[16:19], v[104:107]
    ds_read_b64_tr_b16 v[32:33], v8 offset:0
    buffer_load_dwordx4 v6, s[28:31], s49 offen offset:2048 lds
    v_mfma_f32_16x16x32_bf16 v[120:123], v[48:51], v[16:19], v[120:123]
    ds_read_b64_tr_b16 v[34:35], v8 offset:1536
    s_add_u32 s49, s49, 98304
    v_mfma_f32_16x16x32_bf16 v[136:139], v[52:55], v[16:19], v[136:139]
    ds_read_b64_tr_b16 v[36:37], v8 offset:12288
    s_add_u32 m0, s55, 8192
    v_mfma_f32_16x16x32_bf16 v[108:111], v[44:47], v[20:23], v[108:111]
    ds_read_b128 v[16:19], v12 offset:0
    buffer_load_dwordx4 v2, s[24:27], s56 offen lds
    v_mfma_f32_16x16x32_bf16 v[124:127], v[48:51], v[20:23], v[124:127]
    ds_read_b64_tr_b16 v[38:39], v8 offset:13824
    s_and_b32 s51, s68, 15
    v_mfma_f32_16x16x32_bf16 v[140:143], v[52:55], v[20:23], v[140:143]
    ds_read_b64_tr_b16 v[40:41], v9 offset:0
    s_setprio 2
    v_mfma_f32_16x16x32_bf16 v[112:115], v[44:47], v[24:27], v[112:115]
    ds_read_b128 v[20:23], v12 offset:2048
    s_lshl_b32 s51, s51, 7
    v_mfma_f32_16x16x32_bf16 v[128:131], v[48:51], v[24:27], v[128:131]
    ds_read_b64_tr_b16 v[42:43], v9 offset:1536
    s_lshr_b64 s[68:69], s[68:69], 4
    v_mfma_f32_16x16x32_bf16 v[144:147], v[52:55], v[24:27], v[144:147]
    s_add_u32 s50, s50, 16384
    s_cmp_eq_u32 s50, 49152
    v_mfma_f32_16x16x32_bf16 v[116:119], v[44:47], v[28:31], v[116:119]
    ds_read_b128 v[24:27], v12 offset:4096
    s_cselect_b32 s50, 0, s50
    v_mfma_f32_16x16x32_bf16 v[132:135], v[48:51], v[28:31], v[132:135]
    s_add_u32 s48, s48, s53
    s_sub_u32 s53, 0, s53
    v_mfma_f32_16x16x32_bf16 v[148:151], v[52:55], v[28:31], v[148:151]
    s_setprio 1
    s_add_u32 s47, s47, 1
F_CHK:
    s_bitcmp1_b32 s60, s47
    s_cbranch_scc1 F_SIDE
F_BACK:
    s_cmp_lt_u32 s47, 8
    s_cbranch_scc1 F_LOOP
    s_waitcnt lgkmcnt(1)
    v_mfma_f32_16x16x32_bf16 v[56:59], v[32:35], v[16:19], v[56:59]
    ds_read_b128 v[28:31], v12 offset:6144
    v_mfma_f32_16x16x32_bf16 v[72:75], v[36:39], v[16:19], v[72:75]
    ds_read_b64_tr_b16 v[44:45], v9 offset:12288
    s_add_u32 s54, s48, s53
    v_mfma_f32_16x16x32_bf16 v[88:91], v[40:43], v[16:19], v[88:91]
    ds_read_b64_tr_b16 v[46:47], v9 offset:13824
    v_mfma_f32_16x16x32_bf16 v[60:63], v[32:35], v[20:23], v[60:63]
    ds_read_b64_tr_b16 v[48:49], v10 offset:0
    v_mfma_f32_16x16x32_bf16 v[76:79], v[36:39], v[20:23], v[76:79]
    ds_read_b64_tr_b16 v[50:51], v10 offset:1536
    v_mfma_f32_16x16x32_bf16 v[92:95], v[40:43], v[20:23], v[92:95]
    ds_read_b64_tr_b16 v[52:53], v10 offset:12288
    s_setprio 0
    s_waitcnt lgkmcnt(6)
    v_mfma_f32_16x16x32_bf16 v[64:67], v[32:35], v[24:27], v[64:67]
    ds_read_b64_tr_b16 v[54:55], v10 offset:13824
    v_mfma_f32_16x16x32_bf16 v[80:83], v[36:39], v[24:27], v[80:83]
    s_add_u32 m0, s54, 24576
    v_mfma_f32_16x16x32_bf16 v[96:99], v[40:43], v[24:27], v[96:99]
    buffer_load_dwordx4 v4, s[28:31], s49 offen offset:0 lds
    s_waitcnt lgkmcnt(6)
    v_mfma_f32_16x16x32_bf16 v[68:71], v[32:35], v[28:31], v[68:71]
    buffer_load_dwordx4 v5, s[28:31], s49 offen offset:1024 lds
    buffer_load_dwordx4 v6, s[28:31], s49 offen offset:2048 lds
    v_mfma_f32_16x16x32_bf16 v[84:87], v[36:39], v[28:31], v[84:87]
    v_xor_b32 v13, 64, v12
    v_mfma_f32_16x16x32_bf16 v[100:103], v[40:43], v[28:31], v[100:103]
    s_setprio 3
    s_cmp_lg_u32 s46, 3
    s_cbranch_scc1 F_W2OK
    s_mov_b32 s55, 20000
F_W2CHK:
    v_cmp_ne_u32 s[40:41], s10, v156
    v_cmp_ne_u32 s[42:43], s10, v157
    s_nop 1
    s_or_b64 s[40:41], s[40:41], s[42:43]
    s_cbranch_scc0 F_W2OK
    s_sub_u32 s55, s55, 1
    s_cmp_eq_u32 s55, 0
    s_cbranch_scc1 F_W2OK
    s_sleep 8
    v_lshlrev_b32 v154, 3, v0
    s_mov_b32 s54, 12603392
    buffer_load_dwordx2 v[156:157], v154, s[32:35], s54 offen sc1
    s_waitcnt vmcnt(0)
    s_branch F_W2CHK
F_W2OK:
    s_waitcnt vmcnt(7) lgkmcnt(0)
    s_barrier
    v_mfma_f32_16x16x32_bf16 v[104:107], v[44:47], v[16:19], v[104:107]
    ds_read_b64_tr_b16 v[32:33], v8 offset:24576
    v_mfma_f32_16x16x32_bf16 v[120:123], v[48:51], v[16:19], v[120:123]
    ds_read_b64_tr_b16 v[34:35], v8 offset:26112
    v_mfma_f32_16x16x32_bf16 v[136:139], v[52:55], v[16:19], v[136:139]
    ds_read_b64_tr_b16 v[36:37], v8 offset:36864
    buffer_load_dwordx4 v[156:159], v152, s[32:35], s76 offen offset:0 sc1
    v_mfma_f32_16x16x32_bf16 v[108:111], v[44:47], v[20:23], v[108:111]
    ds_read_b128 v[16:19], v13 offset:0
    v_mfma_f32_16x16x32_bf16 v[124:127], v[48:51], v[20:23], v[124:127]
    ds_read_b64_tr_b16 v[38:39], v8 offset:38400
    v_mfma_f32_16x16x32_bf16 v[140:143], v[52:55], v[20:23], v[140:143]
    ds_read_b64_tr_b16 v[40:41], v9 offset:24576
    s_setprio 2
    v_mfma_f32_16x16x32_bf16 v[112:115], v[44:47], v[24:27], v[112:115]
    ds_read_b128 v[20:23], v13 offset:2048
    v_mfma_f32_16x16x32_bf16 v[128:131], v[48:51], v[24:27], v[128:131]
    ds_read_b64_tr_b16 v[42:43], v9 offset:26112
    v_mfma_f32_16x16x32_bf16 v[144:147], v[52:55], v[24:27], v[144:147]
    buffer_load_dwordx4 v[160:163], v152, s[32:35], s76 offen offset:1024 sc1
    v_mfma_f32_16x16x32_bf16 v[116:119], v[44:47], v[28:31], v[116:119]
    ds_read_b128 v[24:27], v13 offset:4096
    v_mfma_f32_16x16x32_bf16 v[132:135], v[48:51], v[28:31], v[132:135]
    buffer_load_dwordx4 v[164:167], v152, s[32:35], s76 offen offset:2048 sc1
    v_mfma_f32_16x16x32_bf16 v[148:151], v[52:55], v[28:31], v[148:151]
    s_setprio 1
    s_waitcnt lgkmcnt(1)
    v_mfma_f32_16x16x32_bf16 v[56:59], v[32:35], v[16:19], v[56:59]
    ds_read_b128 v[28:31], v13 offset:6144
    buffer_load_dwordx4 v[168:171], v152, s[32:35], s76 offen offset:3072 sc1
    v_mfma_f32_16x16x32_bf16 v[72:75], v[36:39], v[16:19], v[72:75]
    ds_read_b64_tr_b16 v[44:45], v9 offset:36864
    v_mfma_f32_16x16x32_bf16 v[88:91], v[40:43], v[16:19], v[88:91]
    ds_read_b64_tr_b16 v[46:47], v9 offset:38400
    buffer_load_dwordx4 v[172:175], v153, s[32:35], s76 offen offset:0 sc1
    v_mfma_f32_16x16x32_bf16 v[60:63], v[32:35], v[20:23], v[60:63]
    ds_read_b64_tr_b16 v[48:49], v10 offset:24576
    s_add_u32 s76, s76, 5120
    v_mfma_f32_16x16x32_bf16 v[76:79], v[36:39], v[20:23], v[76:79]
    ds_read_b64_tr_b16 v[50:51], v10 offset:26112
    buffer_load_dwordx4 v[176:179], v152, s[32:35], s76 offen offset:0 sc1
    v_mfma_f32_16x16x32_bf16 v[92:95], v[40:43], v[20:23], v[92:95]
    ds_read_b64_tr_b16 v[52:53], v10 offset:36864
    s_setprio 0
    s_waitcnt lgkmcnt(6)
    v_mfma_f32_16x16x32_bf16 v[64:67], v[32:35], v[24:27], v[64:67]
    ds_read_b64_tr_b16 v[54:55], v10 offset:38400
    v_mfma_f32_16x16x32_bf16 v[80:83], v[36:39], v[24:27], v[80:83]
    s_add_u32 s52, s52, 16384
    s_cmp_eq_u32 s52, 49152
    v_mfma_f32_16x16x32_bf16 v[96:99], v[40:43], v[24:27], v[96:99]
    s_cselect_b32 s52, 0, s52
    v_add_u32 v12, s52, v11
    s_waitcnt lgkmcnt(6)
    v_mfma_f32_16x16x32_bf16 v[68:71], v[32:35], v[28:31], v[68:71]
    v_add_u32 v8, s53, v8
    v_mfma_f32_16x16x32_bf16 v[84:87], v[36:39], v[28:31], v[84:87]
    v_add_u32 v9, s53, v9
    v_add_u32 v10, s53, v10
    v_mfma_f32_16x16x32_bf16 v[100:103], v[40:43], v[28:31], v[100:103]
    s_setprio 3
    s_waitcnt vmcnt(6) lgkmcnt(0)
    s_barrier
    v_mfma_f32_16x16x32_bf16 v[104:107], v[44:47], v[16:19], v[104:107]
    v_xor_b32 v13, 64, v12
    ds_read_b64_tr_b16 v[32:33], v8 offset:0
    v_mfma_f32_16x16x32_bf16 v[120:123], v[48:51], v[16:19], v[120:123]
    ds_read_b64_tr_b16 v[34:35], v8 offset:1536
    ds_read_b64_tr_b16 v[36:37], v8 offset:12288
    v_mfma_f32_16x16x32_bf16 v[136:139], v[52:55], v[16:19], v[136:139]
    ds_read_b64_tr_b16 v[38:39], v8 offset:13824
    ds_read_b64_tr_b16 v[40:41], v8 offset:24576
    v_mfma_f32_16x16x32_bf16 v[108:111], v[44:47], v[20:23], v[108:111]
    ds_read_b128 v[16:19], v12 offset:0
    ds_read_b64_tr_b16 v[42:43], v8 offset:26112
    v_mfma_f32_16x16x32_bf16 v[124:127], v[48:51], v[20:23], v[124:127]
    ds_read_b128 v[236:239], v13 offset:0
    ds_read_b128 v[240:243], v13 offset:2048
    v_mfma_f32_16x16x32_bf16 v[140:143], v[52:55], v[20:23], v[140:143]
    ds_read_b128 v[244:247], v13 offset:4096
    ds_read_b128 v[248:251], v13 offset:6144
    v_mfma_f32_16x16x32_bf16 v[112:115], v[44:47], v[24:27], v[112:115]
    ds_read_b128 v[20:23], v12 offset:2048
    v_mfma_f32_16x16x32_bf16 v[128:131], v[48:51], v[24:27], v[128:131]
    v_mfma_f32_16x16x32_bf16 v[144:147], v[52:55], v[24:27], v[144:147]
    buffer_load_dwordx4 v[180:183], v152, s[32:35], s76 offen offset:1024 sc1
    v_mfma_f32_16x16x32_bf16 v[116:119], v[44:47], v[28:31], v[116:119]
    ds_read_b128 v[24:27], v12 offset:4096
    v_mfma_f32_16x16x32_bf16 v[132:135], v[48:51], v[28:31], v[132:135]
    buffer_load_dwordx4 v[184:187], v152, s[32:35], s76 offen offset:2048 sc1
    v_mfma_f32_16x16x32_bf16 v[148:151], v[52:55], v[28:31], v[148:151]
    buffer_load_dwordx4 v[188:191], v152, s[32:35], s76 offen offset:3072 sc1
    s_waitcnt lgkmcnt(7)
    v_mfma_f32_16x16x32_bf16 v[56:59], v[32:35], v[16:19], v[56:59]
    ds_read_b128 v[28:31], v12 offset:6144
    v_mfma_f32_16x16x32_bf16 v[72:75], v[36:39], v[16:19], v[72:75]
    ds_read_b64_tr_b16 v[44:45], v8 offset:36864
    s_waitcnt lgkmcnt(3)
    v_mfma_f32_16x16x32_bf16 v[60:63], v[32:35], v[20:23], v[60:63]
    ds_read_b64_tr_b16 v[46:47], v8 offset:38400
    v_mfma_f32_16x16x32_bf16 v[76:79], v[36:39], v[20:23], v[76:79]
    ds_read_b64_tr_b16 v[48:49], v9 offset:0
    buffer_load_dwordx4 v[192:195], v153, s[32:35], s76 offen offset:0 sc1
    s_waitcnt lgkmcnt(4)
    v_mfma_f32_16x16x32_bf16 v[64:67], v[32:35], v[24:27], v[64:67]
    ds_read_b64_tr_b16 v[50:51], v9 offset:1536
    v_mfma_f32_16x16x32_bf16 v[80:83], v[36:39], v[24:27], v[80:83]
    ds_read_b64_tr_b16 v[52:53], v9 offset:12288
    s_add_u32 s76, s76, 5120
    s_waitcnt lgkmcnt(5)
    v_mfma_f32_16x16x32_bf16 v[68:71], v[32:35], v[28:31], v[68:71]
    ds_read_b64_tr_b16 v[54:55], v9 offset:13824
    v_mfma_f32_16x16x32_bf16 v[84:87], v[36:39], v[28:31], v[84:87]
    buffer_load_dwordx4 v[196:199], v152, s[32:35], s76 offen offset:0 sc1
    buffer_load_dwordx4 v[200:203], v152, s[32:35], s76 offen offset:1024 sc1
    v_mfma_f32_16x16x32_bf16 v[56:59], v[40:43], v[236:239], v[56:59]
    ds_read_b64_tr_b16 v[32:33], v9 offset:24576
    s_waitcnt lgkmcnt(5)
    v_mfma_f32_16x16x32_bf16 v[72:75], v[44:47], v[236:239], v[72:75]
    ds_read_b64_tr_b16 v[34:35], v9 offset:26112
    v_mfma_f32_16x16x32_bf16 v[60:63], v[40:43], v[240:243], v[60:63]
    ds_read_b64_tr_b16 v[36:37], v9 offset:36864
    v_mfma_f32_16x16x32_bf16 v[76:79], v[44:47], v[240:243], v[76:79]
    ds_read_b64_tr_b16 v[38:39], v9 offset:38400
    v_mfma_f32_16x16x32_bf16 v[64:67], v[40:43], v[244:247], v[64:67]
    buffer_load_dwordx4 v[204:207], v152, s[32:35], s76 offen offset:2048 sc1
    v_mfma_f32_16x16x32_bf16 v[80:83], v[44:47], v[244:247], v[80:83]
    buffer_load_dwordx4 v[208:211], v152, s[32:35], s76 offen offset:3072 sc1
    v_mfma_f32_16x16x32_bf16 v[68:71], v[40:43], v[248:251], v[68:71]
    buffer_load_dwordx4 v[212:215], v153, s[32:35], s76 offen offset:0 sc1
    v_mfma_f32_16x16x32_bf16 v[84:87], v[44:47], v[248:251], v[84:87]
    s_add_u32 s76, s76, 5120
    s_nop 4
    v_pk_mul_f32 v[72:73], v[56:57], v[72:73]
    v_pk_mul_f32 v[74:75], v[58:59], v[74:75]
    v_pk_mul_f32 v[76:77], v[60:61], v[76:77]
    v_pk_mul_f32 v[78:79], v[62:63], v[78:79]
    v_pk_mul_f32 v[56:57], v[56:57], s[62:63]
    v_pk_mul_f32 v[58:59], v[58:59], s[62:63]
    v_pk_mul_f32 v[60:61], v[60:61], s[62:63]
    v_pk_mul_f32 v[62:63], v[62:63], s[62:63]
    s_waitcnt lgkmcnt(6)
    v_mfma_f32_16x16x32_bf16 v[88:91], v[48:51], v[16:19], v[88:91]
    v_exp_f32 v56, v56
    ds_read_b64_tr_b16 v[40:41], v10 offset:0
    s_waitcnt lgkmcnt(5)
    v_mfma_f32_16x16x32_bf16 v[104:107], v[52:55], v[16:19], v[104:107]
    v_exp_f32 v57, v57
    ds_read_b64_tr_b16 v[42:43], v10 offset:1536
    v_mfma_f32_16x16x32_bf16 v[92:95], v[48:51], v[20:23], v[92:95]
    v_exp_f32 v58, v58
    ds_read_b64_tr_b16 v[44:45], v10 offset:12288
    v_mfma_f32_16x16x32_bf16 v[108:111], v[52:55], v[20:23], v[108:111]
    v_exp_f32 v59, v59
    ds_read_b64_tr_b16 v[46:47], v10 offset:13824
    v_mfma_f32_16x16x32_bf16 v[96:99], v[48:51], v[24:27], v[96:99]
    v_exp_f32 v60, v60
    buffer_load_dwordx4 v[216:219], v152, s[32:35], s76 offen offset:0 sc1
    v_mfma_f32_16x16x32_bf16 v[112:115], v[52:55], v[24:27], v[112:115]
    v_exp_f32 v61, v61
    v_mfma_f32_16x16x32_bf16 v[100:103], v[48:51], v[28:31], v[100:103]
    v_exp_f32 v62, v62
    buffer_load_dwordx4 v[220:223], v152, s[32:35], s76 offen offset:1024 sc1
    v_mfma_f32_16x16x32_bf16 v[116:119], v[52:55], v[28:31], v[116:119]
    v_exp_f32 v63, v63
    v_pk_add_f32 v[56:57], v[56:57], 1.0 op_sel_hi:[1,0]
    v_pk_add_f32 v[58:59], v[58:59], 1.0 op_sel_hi:[1,0]
    v_pk_add_f32 v[60:61], v[60:61], 1.0 op_sel_hi:[1,0]
    v_pk_add_f32 v[62:63], v[62:63], 1.0 op_sel_hi:[1,0]
    s_waitcnt lgkmcnt(6)
    v_mfma_f32_16x16x32_bf16 v[88:91], v[32:35], v[236:239], v[88:91]
    v_rcp_f32 v56, v56
    ds_read_b64_tr_b16 v[48:49], v10 offset:24576
    s_waitcnt lgkmcnt(5)
    v_mfma_f32_16x16x32_bf16 v[104:107], v[36:39], v[236:239], v[104:107]
    v_rcp_f32 v57, v57
    ds_read_b64_tr_b16 v[50:51], v10 offset:26112
    v_mfma_f32_16x16x32_bf16 v[92:95], v[32:35], v[240:243], v[92:95]
    v_rcp_f32 v58, v58
    ds_read_b64_tr_b16 v[52:53], v10 offset:36864
    v_mfma_f32_16x16x32_bf16 v[108:111], v[36:39], v[240:243], v[108:111]
    v_rcp_f32 v59, v59
    ds_read_b64_tr_b16 v[54:55], v10 offset:38400
    v_mfma_f32_16x16x32_bf16 v[96:99], v[32:35], v[244:247], v[96:99]
    v_rcp_f32 v60, v60
    buffer_load_dwordx4 v[224:227], v152, s[32:35], s76 offen offset:2048 sc1
    v_mfma_f32_16x16x32_bf16 v[112:115], v[36:39], v[244:247], v[112:115]
    v_rcp_f32 v61, v61
    v_mfma_f32_16x16x32_bf16 v[100:103], v[32:35], v[248:251], v[100:103]
    v_rcp_f32 v62, v62
    buffer_load_dwordx4 v[228:231], v152, s[32:35], s76 offen offset:3072 sc1
    v_mfma_f32_16x16x32_bf16 v[116:119], v[36:39], v[248:251], v[116:119]
    v_rcp_f32 v63, v63
    v_pk_mul_f32 v[72:73], v[72:73], v[56:57]
    v_pk_mul_f32 v[74:75], v[74:75], v[58:59]
    v_pk_mul_f32 v[76:77], v[76:77], v[60:61]
    v_pk_mul_f32 v[78:79], v[78:79], v[62:63]
    v_cvt_pk_bf16_f32 v56, v72, v73
    v_cvt_pk_bf16_f32 v58, v76, v77
    v_cvt_pk_bf16_f32 v57, v74, v75
    v_cvt_pk_bf16_f32 v59, v78, v79
    v_permlane16_swap_b32 v56, v58
    s_nop 0
    v_permlane16_swap_b32 v57, v59
    buffer_store_dwordx4 v[56:59], v152, s[32:35], s36 offen offset:0 sc1
    v_pk_mul_f32 v[80:81], v[64:65], v[80:81]
    v_pk_mul_f32 v[82:83], v[66:67], v[82:83]
    v_pk_mul_f32 v[84:85], v[68:69], v[84:85]
    v_pk_mul_f32 v[86:87], v[70:71], v[86:87]
    v_pk_mul_f32 v[64:65], v[64:65], s[62:63]
    v_pk_mul_f32 v[66:67], v[66:67], s[62:63]
    v_pk_mul_f32 v[68:69], v[68:69], s[62:63]
    v_pk_mul_f32 v[70:71], v[70:71], s[62:63]
    s_waitcnt lgkmcnt(6)
    v_mfma_f32_16x16x32_bf16 v[120:123], v[40:43], v[16:19], v[120:123]
    v_exp_f32 v64, v64
    s_waitcnt lgkmcnt(4)
    v_mfma_f32_16x16x32_bf16 v[136:139], v[44:47], v[16:19], v[136:139]
    v_exp_f32 v65, v65
    v_mfma_f32_16x16x32_bf16 v[124:127], v[40:43], v[20:23], v[124:127]
    v_exp_f32 v66, v66
    v_mfma_f32_16x16x32_bf16 v[140:143], v[44:47], v[20:23], v[140:143]
    v_exp_f32 v67, v67
    v_mfma_f32_16x16x32_bf16 v[128:131], v[40:43], v[24:27], v[128:131]
    v_exp_f32 v68, v68
    buffer_load_dwordx4 v[232:235], v153, s[32:35], s76 offen offset:0 sc1
    v_mfma_f32_16x16x32_bf16 v[144:147], v[44:47], v[24:27], v[144:147]
    v_exp_f32 v69, v69
    v_mfma_f32_16x16x32_bf16 v[132:135], v[40:43], v[28:31], v[132:135]
    v_exp_f32 v70, v70
    s_add_u32 s76, s76, 5120
    v_mfma_f32_16x16x32_bf16 v[148:151], v[44:47], v[28:31], v[148:151]
    v_exp_f32 v71, v71
    v_pk_add_f32 v[64:65], v[64:65], 1.0 op_sel_hi:[1,0]
    v_pk_add_f32 v[66:67], v[66:67], 1.0 op_sel_hi:[1,0]
    v_pk_add_f32 v[68:69], v[68:69], 1.0 op_sel_hi:[1,0]
    v_pk_add_f32 v[70:71], v[70:71], 1.0 op_sel_hi:[1,0]
    s_waitcnt lgkmcnt(2)
    v_mfma_f32_16x16x32_bf16 v[120:123], v[48:51], v[236:239], v[120:123]
    v_rcp_f32 v64, v64
    s_waitcnt lgkmcnt(0)
    v_mfma_f32_16x16x32_bf16 v[136:139], v[52:55], v[236:239], v[136:139]
    v_rcp_f32 v65, v65
    v_mfma_f32_16x16x32_bf16 v[124:127], v[48:51], v[240:243], v[124:127]
    v_rcp_f32 v66, v66
    v_mfma_f32_16x16x32_bf16 v[140:143], v[52:55], v[240:243], v[140:143]
    v_rcp_f32 v67, v67
    v_mfma_f32_16x16x32_bf16 v[128:131], v[48:51], v[244:247], v[128:131]
    v_rcp_f32 v68, v68
    v_mfma_f32_16x16x32_bf16 v[144:147], v[52:55], v[244:247], v[144:147]
    v_rcp_f32 v69, v69
    v_mfma_f32_16x16x32_bf16 v[132:135], v[48:51], v[248:251], v[132:135]
    v_rcp_f32 v70, v70
    v_mfma_f32_16x16x32_bf16 v[148:151], v[52:55], v[248:251], v[148:151]
    v_rcp_f32 v71, v71
    v_pk_mul_f32 v[80:81], v[80:81], v[64:65]
    v_pk_mul_f32 v[82:83], v[82:83], v[66:67]
    v_pk_mul_f32 v[84:85], v[84:85], v[68:69]
    v_pk_mul_f32 v[86:87], v[86:87], v[70:71]
    v_cvt_pk_bf16_f32 v64, v80, v81
    v_cvt_pk_bf16_f32 v66, v84, v85
    v_cvt_pk_bf16_f32 v65, v82, v83
    v_cvt_pk_bf16_f32 v67, v86, v87
    v_permlane16_swap_b32 v64, v66
    s_nop 0
    v_permlane16_swap_b32 v65, v67
    buffer_store_dwordx4 v[64:67], v152, s[32:35], s37 offen offset:0 sc1
    v_pk_mul_f32 v[104:105], v[88:89], v[104:105]
    v_pk_mul_f32 v[106:107], v[90:91], v[106:107]
    v_pk_mul_f32 v[108:109], v[92:93], v[108:109]
    v_pk_mul_f32 v[110:111], v[94:95], v[110:111]
    v_pk_mul_f32 v[88:89], v[88:89], s[62:63]
    v_pk_mul_f32 v[90:91], v[90:91], s[62:63]
    v_pk_mul_f32 v[92:93], v[92:93], s[62:63]
    v_pk_mul_f32 v[94:95], v[94:95], s[62:63]
    v_exp_f32 v88, v88
    v_exp_f32 v89, v89
    v_exp_f32 v90, v90
    v_exp_f32 v91, v91
    v_exp_f32 v92, v92
    v_exp_f32 v93, v93
    v_exp_f32 v94, v94
    v_exp_f32 v95, v95
    v_pk_add_f32 v[88:89], v[88:89], 1.0 op_sel_hi:[1,0]
    v_pk_add_f32 v[90:91], v[90:91], 1.0 op_sel_hi:[1,0]
    v_pk_add_f32 v[92:93], v[92:93], 1.0 op_sel_hi:[1,0]
    v_pk_add_f32 v[94:95], v[94:95], 1.0 op_sel_hi:[1,0]
    v_rcp_f32 v88, v88
    v_rcp_f32 v89, v89
    v_rcp_f32 v90, v90
    v_rcp_f32 v91, v91
    v_rcp_f32 v92, v92
    v_rcp_f32 v93, v93
    v_rcp_f32 v94, v94
    v_rcp_f32 v95, v95
    v_pk_mul_f32 v[104:105], v[104:105], v[88:89]
    v_pk_mul_f32 v[106:107], v[106:107], v[90:91]
    v_pk_mul_f32 v[108:109], v[108:109], v[92:93]
    v_pk_mul_f32 v[110:111], v[110:111], v[94:95]
    v_cvt_pk_bf16_f32 v88, v104, v105
    v_cvt_pk_bf16_f32 v90, v108, v109
    v_cvt_pk_bf16_f32 v89, v106, v107
    v_cvt_pk_bf16_f32 v91, v110, v111
    v_permlane16_swap_b32 v88, v90
    s_nop 0
    v_permlane16_swap_b32 v89, v91
    buffer_store_dwordx4 v[88:91], v152, s[32:35], s36 offen offset:1024 sc1
    v_pk_mul_f32 v[112:113], v[96:97], v[112:113]
    v_pk_mul_f32 v[114:115], v[98:99], v[114:115]
    v_pk_mul_f32 v[116:117], v[100:101], v[116:117]
    v_pk_mul_f32 v[118:119], v[102:103], v[118:119]
    v_pk_mul_f32 v[96:97], v[96:97], s[62:63]
    v_pk_mul_f32 v[98:99], v[98:99], s[62:63]
    v_pk_mul_f32 v[100:101], v[100:101], s[62:63]
    v_pk_mul_f32 v[102:103], v[102:103], s[62:63]
    v_exp_f32 v96, v96
    v_exp_f32 v97, v97
    v_exp_f32 v98, v98
    v_exp_f32 v99, v99
    v_exp_f32 v100, v100
    v_exp_f32 v101, v101
    v_exp_f32 v102, v102
    v_exp_f32 v103, v103
    v_pk_add_f32 v[96:97], v[96:97], 1.0 op_sel_hi:[1,0]
    v_pk_add_f32 v[98:99], v[98:99], 1.0 op_sel_hi:[1,0]
    v_pk_add_f32 v[100:101], v[100:101], 1.0 op_sel_hi:[1,0]
    v_pk_add_f32 v[102:103], v[102:103], 1.0 op_sel_hi:[1,0]
    v_rcp_f32 v96, v96
    v_rcp_f32 v97, v97
    v_rcp_f32 v98, v98
    v_rcp_f32 v99, v99
    v_rcp_f32 v100, v100
    v_rcp_f32 v101, v101
    v_rcp_f32 v102, v102
    v_rcp_f32 v103, v103
    v_pk_mul_f32 v[112:113], v[112:113], v[96:97]
    v_pk_mul_f32 v[114:115], v[114:115], v[98:99]
    v_pk_mul_f32 v[116:117], v[116:117], v[100:101]
    v_pk_mul_f32 v[118:119], v[118:119], v[102:103]
    v_cvt_pk_bf16_f32 v96, v112, v113
    v_cvt_pk_bf16_f32 v98, v116, v117
    v_cvt_pk_bf16_f32 v97, v114, v115
    v_cvt_pk_bf16_f32 v99, v118, v119
    v_permlane16_swap_b32 v96, v98
    s_nop 0
    v_permlane16_swap_b32 v97, v99
    buffer_store_dwordx4 v[96:99], v152, s[32:35], s37 offen offset:1024 sc1
    v_pk_mul_f32 v[136:137], v[120:121], v[136:137]
    v_pk_mul_f32 v[138:139], v[122:123], v[138:139]
    v_pk_mul_f32 v[140:141], v[124:125], v[140:141]
    v_pk_mul_f32 v[142:143], v[126:127], v[142:143]
    v_pk_mul_f32 v[120:121], v[120:121], s[62:63]
    v_pk_mul_f32 v[122:123], v[122:123], s[62:63]
    v_pk_mul_f32 v[124:125], v[124:125], s[62:63]
    v_pk_mul_f32 v[126:127], v[126:127], s[62:63]
    v_exp_f32 v120, v120
    v_exp_f32 v121, v121
    v_exp_f32 v122, v122
    v_exp_f32 v123, v123
    v_exp_f32 v124, v124
    v_exp_f32 v125, v125
    v_exp_f32 v126, v126
    v_exp_f32 v127, v127
    v_pk_add_f32 v[120:121], v[120:121], 1.0 op_sel_hi:[1,0]
    v_pk_add_f32 v[122:123], v[122:123], 1.0 op_sel_hi:[1,0]
    v_pk_add_f32 v[124:125], v[124:125], 1.0 op_sel_hi:[1,0]
    v_pk_add_f32 v[126:127], v[126:127], 1.0 op_sel_hi:[1,0]
    v_rcp_f32 v120, v120
    v_rcp_f32 v121, v121
    v_rcp_f32 v122, v122
    v_rcp_f32 v123, v123
    v_rcp_f32 v124, v124
    v_rcp_f32 v125, v125
    v_rcp_f32 v126, v126
    v_rcp_f32 v127, v127
    v_pk_mul_f32 v[136:137], v[136:137], v[120:121]
    v_pk_mul_f32 v[138:139], v[138:139], v[122:123]
    v_pk_mul_f32 v[140:141], v[140:141], v[124:125]
    v_pk_mul_f32 v[142:143], v[142:143], v[126:127]
    v_cvt_pk_bf16_f32 v120, v136, v137
    v_cvt_pk_bf16_f32 v122, v140, v141
    v_cvt_pk_bf16_f32 v121, v138, v139
    v_cvt_pk_bf16_f32 v123, v142, v143
    v_permlane16_swap_b32 v120, v122
    s_nop 0
    v_permlane16_swap_b32 v121, v123
    buffer_store_dwordx4 v[120:123], v152, s[32:35], s36 offen offset:2048 sc1
    v_pk_mul_f32 v[144:145], v[128:129], v[144:145]
    v_pk_mul_f32 v[146:147], v[130:131], v[146:147]
    v_pk_mul_f32 v[148:149], v[132:133], v[148:149]
    v_pk_mul_f32 v[150:151], v[134:135], v[150:151]
    v_pk_mul_f32 v[128:129], v[128:129], s[62:63]
    v_pk_mul_f32 v[130:131], v[130:131], s[62:63]
    v_pk_mul_f32 v[132:133], v[132:133], s[62:63]
    v_pk_mul_f32 v[134:135], v[134:135], s[62:63]
    v_exp_f32 v128, v128
    v_exp_f32 v129, v129
    v_exp_f32 v130, v130
    v_exp_f32 v131, v131
    v_exp_f32 v132, v132
    v_exp_f32 v133, v133
    v_exp_f32 v134, v134
    v_exp_f32 v135, v135
    v_pk_add_f32 v[128:129], v[128:129], 1.0 op_sel_hi:[1,0]
    v_pk_add_f32 v[130:131], v[130:131], 1.0 op_sel_hi:[1,0]
    v_pk_add_f32 v[132:133], v[132:133], 1.0 op_sel_hi:[1,0]
    v_pk_add_f32 v[134:135], v[134:135], 1.0 op_sel_hi:[1,0]
    v_rcp_f32 v128, v128
    v_rcp_f32 v129, v129
    v_rcp_f32 v130, v130
    v_rcp_f32 v131, v131
    v_rcp_f32 v132, v132
    v_rcp_f32 v133, v133
    v_rcp_f32 v134, v134
    v_rcp_f32 v135, v135
    v_pk_mul_f32 v[144:145], v[144:145], v[128:129]
    v_pk_mul_f32 v[146:147], v[146:147], v[130:131]
    v_pk_mul_f32 v[148:149], v[148:149], v[132:133]
    v_pk_mul_f32 v[150:151], v[150:151], v[134:135]
    v_cvt_pk_bf16_f32 v128, v144, v145
    v_cvt_pk_bf16_f32 v130, v148, v149
    v_cvt_pk_bf16_f32 v129, v146, v147
    v_cvt_pk_bf16_f32 v131, v150, v151
    v_permlane16_swap_b32 v128, v130
    s_nop 0
    v_permlane16_swap_b32 v129, v131
    buffer_store_dwordx4 v[128:131], v152, s[32:35], s37 offen offset:2048 sc1
    s_setprio 0
    buffer_load_dwordx4 v[236:239], v152, s[32:35], s76 offen offset:0 sc1
    buffer_load_dwordx4 v[240:243], v152, s[32:35], s76 offen offset:1024 sc1
    buffer_load_dwordx4 v[244:247], v152, s[32:35], s76 offen offset:2048 sc1
    buffer_load_dwordx4 v[248:251], v152, s[32:35], s76 offen offset:3072 sc1
    buffer_load_dwordx4 v[252:255], v153, s[32:35], s76 offen offset:0 sc1
    s_add_u32 s76, s76, 5120
    s_mul_i32 s58, s46, 20480
    s_mov_b32 s68, s72
    s_and_b32 s69, s73, 0xffff
    s_mov_b32 s70, 2621440
    s_mov_b32 s71, 0x00020000
    v_lshrrev_b32 v9, 4, v0
    v_and_b32 v1, 15, v0
    v_lshlrev_b32 v4, 9, v9
    v_lshl_add_u32 v4, v1, 4, v4
    v_add_u32 v5, 139264, v4
    v_add_u32 v6, s58, v152
    v_add_u32 v7, 139264, v152
    v_and_b32 v10, 1, v9
    v_lshlrev_b32 v10, 7, v10
    v_xor_b32 v144, v10, v6
    v_xor_b32 v145, 64, v144
    v_lshlrev_b32 v10, 6, v9
    v_xor_b32 v146, v10, v6
    v_lshrrev_b32 v10, 3, v0
    s_and_b32 s54, s46, 1
    s_lshl_b32 s54, s54, 3
    v_add_u32 v10, s54, v10
    v_bfe_u32 v11, v0, 1, 2
    v_and_b32 v12, 1, v0
    v_and_b32 v13, 3, v0
    v_lshlrev_b32 v13, 2, v13
    v_xor_b32 v13, v13, v10
    v_lshlrev_b32 v13, 4, v13
    v_lshl_add_u32 v13, v11, 8, v13
    v_mul_u32_u24 v14, 3072, v12
    s_lshr_b32 s55, s46, 1
    s_mul_i32 s56, s55, 5120
    v_add3_u32 v147, v13, v14, s56
    v_lshlrev_b32 v13, 2, v11
    v_xor_b32 v13, v13, v10
    v_lshlrev_b32 v13, 4, v13
    v_lshl_add_u32 v13, v11, 8, v13
    v_lshl_add_u32 v13, v12, 3, v13
    s_add_u32 s56, s56, 2048
    v_add_u32 v148, s56, v13
    v_mul_u32_u24 v13, 2560, v10
    v_mul_u32_u24 v14, 40, v11
    v_add_u32 v13, v13, v14
    v_mul_u32_u24 v14, 24, v12
    v_add_u32 v149, v13, v14
    v_lshl_add_u32 v150, v12, 2, v13
    v_lshlrev_b32 v151, 2, v10
    s_bfe_u32 s57, s81, 0x40000
    s_lshl_b32 s57, s57, 11
    s_add_u32 s36, s80, s57
    s_bfe_u32 s57, s81, 0x40004
    s_lshl_b32 s57, s57, 11
    s_add_u32 s37, s80, s57
    s_bfe_u32 s57, s81, 0x40008
    s_lshl_b32 s57, s57, 11
    s_add_u32 s38, s80, s57
    s_bfe_u32 s57, s81, 0x4000c
    s_lshl_b32 s57, s57, 11
    s_add_u32 s39, s80, s57
    s_bfe_u32 s57, s81, 0x40010
    s_lshl_b32 s57, s57, 11
    s_add_u32 s40, s80, s57
    s_bfe_u32 s57, s81, 0x40014
    s_lshl_b32 s57, s57, 11
    s_add_u32 s41, s80, s57
    s_bfe_u32 s57, s81, 0x40018
    s_lshl_b32 s57, s57, 11
    s_add_u32 s42, s80, s57
    s_bfe_u32 s57, s81, 0x4001c
    s_lshl_b32 s57, s57, 11
    s_add_u32 s43, s80, s57
    s_add_u32 s24, s80, 16384
    s_mov_b32 s28, s20
    s_and_b32 s29, s21, 0xffff
    s_mov_b32 s30, 12607488
    s_mov_b32 s31, 0x00020000
    s_cmp_ge_u32 s46, 4
    s_cselect_b32 s30, 0, s30
    s_lshr_b32 s54, s46, 1
    s_lshl_b32 s25, s22, 2
    s_add_u32 s25, s25, s54
    s_lshl_b32 s25, s25, 6
    s_add_u32 s25, s25, 12582912
    s_lshl_b32 s26, s22, 6
    s_and_b32 s57, s54, 1
    s_lshl_b32 s57, s57, 5
    s_add_u32 s26, s26, s57
    s_lshr_b32 s57, s54, 1
    s_add_u32 s26, s26, s57
    s_mul_i32 s26, s26, 1280
    s_mul_i32 s57, s23, 160
    s_add_u32 s26, s26, s57
    s_waitcnt vmcnt(5)
    s_branch P2_ENTRY
F_SIDE:
    s_cmp_lg_u32 s46, 3
    s_cbranch_scc1 F_BACK
    s_cmp_eq_u32 s47, 7
    s_cbranch_scc1 F_FLD
    s_cmp_lg_u32 s47, 6
    s_cbranch_scc1 F_BACK
    buffer_load_dword v154, off, s[64:67], 0 sc1
    s_branch F_BACK
F_FLD:
    s_mov_b32 s55, 20000
F_NCHK:
    v_readfirstlane_b32 s10, v154
    s_nop 1
    s_cmp_lg_u32 s10, 0
    s_cbranch_scc1 F_NOK
    s_sub_u32 s55, s55, 1
    s_cmp_eq_u32 s55, 0
    s_cbranch_scc1 F_NOK
    s_sleep 8
    buffer_load_dword v154, off, s[64:67], 0 sc1
    s_waitcnt vmcnt(0)
    s_branch F_NCHK
F_NOK:
    v_lshlrev_b32 v154, 3, v0
    s_mov_b32 s54, 12603392
    buffer_load_dwordx2 v[156:157], v154, s[32:35], s54 offen sc1
    s_branch F_BACK
K_QKV:
    s_mul_i32 s56, s46, 15360
    s_mul_i32 s57, s45, 160
    s_add_u32 s56, s56, s57
    s_and_b32 s57, s46, 2
    s_lshl_b32 s57, s57, 2
    v_xor_b32 v7, s57, v1
    v_add_u32 v144, 0, v3
    v_lshlrev_b32 v145, 1, v144
    v_xor_b32 v145, v145, v7
    v_min_u32 v145, 29, v145
    v_mul_u32_u24 v146, 205, v145
    v_lshrrev_b32 v146, 11, v146
    v_mul_u32_u24 v4, 1120, v146
    v_lshl_add_u32 v4, v145, 4, v4
    v_add_u32 v4, 1280, v4
    v_cmp_eq_u32 vcc, 2, v146
    v_mov_b32 v145, 3840
    s_nop 0
    v_cndmask_b32 v145, 0, v145, vcc
    v_sub_u32 v4, v4, v145
    v_mul_u32_u24 v144, 3840, v144
    v_add3_u32 v4, v4, v144, s56
    s_sub_u32 s56, s56, 1024
    v_add_u32 v144, 2, v3
    v_lshlrev_b32 v145, 1, v144
    v_xor_b32 v145, v145, v7
    v_min_u32 v145, 29, v145
    v_mul_u32_u24 v146, 205, v145
    v_lshrrev_b32 v146, 11, v146
    v_mul_u32_u24 v5, 1120, v146
    v_lshl_add_u32 v5, v145, 4, v5
    v_add_u32 v5, 1280, v5
    v_cmp_eq_u32 vcc, 2, v146
    v_mov_b32 v145, 3840
    s_nop 0
    v_cndmask_b32 v145, 0, v145, vcc
    v_sub_u32 v5, v5, v145
    v_mul_u32_u24 v144, 3840, v144
    v_add3_u32 v5, v5, v144, s56
    s_sub_u32 s56, s56, 1024
    s_lshl_b32 s56, s44, 7
    s_min_u32 s56, s56, 16
    s_mul_i32 s57, s46, 15
    s_add_u32 s56, s56, s57
    s_mul_i32 s56, s56, 1280
    v_subrev_u32 v6, s56, v2
    s_lshl_b32 s48, s46, 11
    s_lshl_b32 s59, s46, 10
    s_add_u32 s58, s59, 67584
    s_add_u32 s59, s59, 65536
    s_mul_i32 s54, s46, 160
    v_lshlrev_b32 v144, 4, v0
    s_waitcnt lgkmcnt(0)
    s_mov_b32 s24, s4
    s_and_b32 s25, s5, 0xffff
    s_mov_b32 s26, 2621440
    s_mov_b32 s27, 0x00020000
    s_mov_b32 s28, s6
    s_and_b32 s29, s7, 0xffff
    s_mov_b32 s30, 2457600
    s_mov_b32 s31, 0x00020000
    s_mov_b32 s64, s74
    s_and_b32 s65, s75, 0xffff
    s_mov_b32 s66, 256
    s_mov_b32 s67, 0x00020000
    v_mov_b32 v154, s68
    v_mov_b32 v155, s69
    s_and_b32 s51, s68, 15
    s_lshl_b32 s51, s51, 7
    s_lshr_b64 s[68:69], s[68:69], 4
    s_mul_i32 s49, s51, 1920
    s_cmp_ge_u32 s46, 2
    s_cbranch_scc1 QH1
    s_add_u32 m0, s59, 0
    s_nop 0
    buffer_load_dwordx4 v6, s[24:27], s51 offen lds
QH1:
    s_add_u32 m0, s58, 0
    s_add_u32 s56, s51, 0
    buffer_load_dwordx4 v2, s[24:27], s56 offen lds
    s_add_u32 m0, s58, 8192
    s_add_u32 s56, s51, 81920
    buffer_load_dwordx4 v2, s[24:27], s56 offen lds
    s_add_u32 m0, s48, 0
    s_add_u32 s57, s49, 0
    buffer_load_dwordx4 v4, s[28:31], s57 offen offset:0 lds
    buffer_load_dwordx4 v5, s[28:31], s57 offen offset:1024 lds
    s_mov_b32 s36, s18
    s_and_b32 s37, s19, 0xffff
    s_mov_b32 s38, 1280
    s_mov_b32 s39, 0x00020000
    s_add_u32 m0, s54, 120832
    v_add_u32 v144, s54, v144
    v_lshrrev_b32 v145, 7, v144
    v_lshlrev_b32 v145, 2, v145
    v_lshrrev_b64 v[154:155], v145, v[154:155]
    v_and_b32 v145, 15, v154
    v_and_b32 v144, 127, v144
    v_lshl_add_u32 v144, v145, 7, v144
    s_mov_b64 exec, 0x3ff
    buffer_load_dwordx4 v144, s[36:39], 0 offen lds
    s_mov_b64 exec, -1
    s_barrier
    s_mov_b32 s32, s20
    s_and_b32 s33, s21, 0xffff
    s_mov_b32 s34, 12607488
    s_mov_b32 s35, 0x00020000
    s_lshr_b32 s56, s2, 3
    s_and_b32 s56, s56, 15
    s_cmp_lg_u32 s56, 0
    s_cbranch_scc1 CT1279
    s_cmp_ge_u32 s46, 3
    s_cbranch_scc1 CT1279
    s_getpc_b64 s[56:57]
CT1279p:
    s_sub_u32 s56, s56, CT1279p-gated_mix__sliding_local_dilated__swiglu_ffn__prompt_kernel
    s_subb_u32 s57, s57, 0
    v_lshlrev_b32 v158, 7, v0
    s_lshl_b32 s10, s46, 13
    v_add_u32 v158, s10, v158
    v_min_u32 v158, K_END-gated_mix__sliding_local_dilated__swiglu_ffn__prompt_kernel, v158
    global_load_dword v158, v158, s[56:57]
CT1279:
    v_and_b32 v145, 15, v0
    v_lshrrev_b32 v146, 4, v0
    v_lshrrev_b32 v144, 1, v145
    v_xor_b32 v144, v144, v146
    v_lshlrev_b32 v144, 4, v144
    v_lshl_add_u32 v12, v145, 7, v144
    v_add_u32 v12, 65536, v12
    v_mov_b32 v13, v12
    s_and_b32 s54, s46, 1
    s_lshl_b32 s56, s54, 13
    s_add_u32 s56, s56, 2048
    v_add_u32 v9, s56, v12
    v_mov_b32 v10, v9
    s_lshr_b32 s55, s46, 1
    s_lshr_b32 s56, s46, 2
    s_xor_b32 s55, s55, s56
    s_lshl_b32 s11, s55, 2
    s_lshl_b32 s54, s54, 1
    s_cmp_lt_u32 s46, 4
    s_cselect_b32 s54, s54, 0
    s_xor_b32 s11, s11, s54
    v_bfe_u32 v145, v0, 2, 2
    v_bfe_u32 v144, v0, 2, 3
    v_xor_b32 v144, s11, v144
    v_lshl_add_u32 v145, v146, 3, v145
    v_lshlrev_b32 v145, 9, v145
    v_lshl_add_u32 v8, v144, 5, v145
    v_and_b32 v144, 3, v0
    v_lshl_add_u32 v8, v144, 3, v8
    v_xor_b32 v147, 32, v8
    v_xor_b32 v148, 64, v8
    v_xor_b32 v149, 0x60, v8
    v_lshlrev_b32 v15, 4, v146
    v_add_u32 v15, 120832, v15
    s_cmp_eq_u32 s55, 3
    s_cselect_b64 s[62:63], -1, 0
    s_lshl_b32 s61, s44, 3
    s_add_u32 s61, s61, s45
    s_and_b32 s54, s2, 7
    s_lshr_b32 s55, s2, 3
    s_lshl_b32 s22, s54, 2
    s_and_b32 s56, s55, 3
    s_add_u32 s22, s22, s56
    s_lshr_b32 s23, s55, 2
    s_and_b32 s22, s54, 3
    s_lshl_b32 s22, s22, 3
    s_and_b32 s56, s55, 7
    s_add_u32 s22, s22, s56
    s_and_b32 s23, s54, 4
    s_lshr_b32 s56, s55, 3
    s_add_u32 s23, s23, s56
    s_lshl_b32 s54, s46, 3
    s_add_u32 s54, s54, 4
    s_mul_i32 s55, s46, 9
    s_cmp_lt_u32 s46, 4
    s_cselect_b32 s54, s55, s54
    s_mul_i32 s56, s23, 68
    s_add_u32 s56, s56, s54
    s_mul_i32 s56, s56, 5120
    s_add_u32 s77, s56, 9437184
    s_mul_i32 s56, s22, 278528
    s_lshl_b32 s54, s54, 11
    s_add_u32 s80, s56, s54
    s_mov_b32 s78, 0x76543210
    s_mov_b32 s79, 8
    v_lshlrev_b32 v152, 4, v0
    v_add_u32 v153, 4096, v152
    s_mov_b32 s81, s78
    s_mov_b32 s76, s77
    s_cmp_eq_u32 s46, 3
    s_cselect_b32 s60, 142, 6
    s_mov_b32 s50, 36864
    s_mov_b32 s52, 0
    s_mov_b32 s54, 0x4f
    s_bitcmp1_b32 s54, s46
    s_cselect_b64 vcc, -1, 0
    s_add_u32 m0, s48, 16384
    s_add_u32 s57, s49, 122880
    buffer_load_dwordx4 v4, s[28:31], s57 offen offset:0 lds
    buffer_load_dwordx4 v5, s[28:31], s57 offen offset:1024 lds
    s_and_b32 s51, s68, 15
    s_lshl_b32 s51, s51, 7
    s_lshr_b64 s[68:69], s[68:69], 4
    s_mul_i32 s49, s51, 1920
    s_waitcnt vmcnt(2)
    s_barrier
    ds_read_b64_tr_b16 v[52:53], v8 offset:0
    ds_read_b64_tr_b16 v[54:55], v8 offset:2048
    ds_read_b128 v[16:19], v10 offset:0
    ds_read_b64_tr_b16 v[56:57], v147 offset:0
    ds_read_b64_tr_b16 v[58:59], v147 offset:2048
    ds_read_b128 v[20:23], v10 offset:2048
    ds_read_b128 v[24:27], v10 offset:4096
    ds_read_b128 v[28:31], v10 offset:6144
    ds_read_b128 v[48:51], v13
    s_waitcnt lgkmcnt(4)
    v_mfma_f32_16x16x32_bf16 v[68:71], v[52:55], v[16:19], 0
    ds_read_b64_tr_b16 v[60:61], v148 offset:0
    v_mfma_f32_16x16x32_bf16 v[84:87], v[56:59], v[16:19], 0
    ds_read_b64_tr_b16 v[62:63], v148 offset:2048
    s_cmp_ge_u32 s46, 2
    s_cbranch_scc1 QH2
    s_add_u32 m0, s59, 18432
    s_nop 0
    buffer_load_dwordx4 v6, s[24:27], s51 offen lds
QH2:
    s_waitcnt lgkmcnt(5)
    v_mfma_f32_16x16x32_bf16 v[72:75], v[52:55], v[20:23], 0
    ds_read_b64_tr_b16 v[64:65], v149 offset:0
    s_add_u32 m0, s58, 18432
    s_nop 0
    buffer_load_dwordx4 v2, s[24:27], s51 offen lds
    v_mfma_f32_16x16x32_bf16 v[88:91], v[56:59], v[20:23], 0
    ds_read_b64_tr_b16 v[66:67], v149 offset:2048
    s_add_u32 m0, s48, 32768
    s_nop 0
    buffer_load_dwordx4 v4, s[28:31], s49 offen offset:0 lds
    s_waitcnt lgkmcnt(6)
    v_mfma_f32_16x16x32_bf16 v[76:79], v[52:55], v[24:27], 0
    s_mov_b64 exec, s[62:63]
    ds_read_b128 v[64:67], v15 offset:0
    s_mov_b64 exec, -1
    v_mfma_f32_16x16x32_bf16 v[92:95], v[56:59], v[24:27], 0
    buffer_load_dwordx4 v5, s[28:31], s49 offen offset:1024 lds
    s_add_u32 m0, s58, 26624
    s_add_u32 s56, s51, 81920
    buffer_load_dwordx4 v2, s[24:27], s56 offen lds
    s_waitcnt lgkmcnt(5)
    v_mfma_f32_16x16x32_bf16 v[80:83], v[52:55], v[28:31], 0
    s_add_u32 s49, s49, 122880
    s_and_b32 s51, s68, 15
    s_lshl_b32 s51, s51, 7
    v_mfma_f32_16x16x32_bf16 v[96:99], v[56:59], v[28:31], 0
    s_lshr_b64 s[68:69], s[68:69], 4
    v_xor_b32 v11, 64, v10
    v_xor_b32 v14, 64, v13
    s_waitcnt lgkmcnt(4)
    s_cbranch_vccz QS4
    v_mfma_f32_16x16x32_bf16 v[132:135], v[52:55], v[48:51], 0
    v_mfma_f32_16x16x32_bf16 v[136:139], v[56:59], v[48:51], 0
QS4:
    s_waitcnt vmcnt(4) lgkmcnt(0)
    s_barrier
    v_mfma_f32_16x16x32_bf16 v[100:103], v[60:63], v[16:19], 0
    ds_read_b64_tr_b16 v[52:53], v8 offset:16384
    s_xor_b32 m0, s48, 49152
    s_nop 0
    buffer_load_dwordx4 v4, s[28:31], s49 offen offset:0 lds
    v_mfma_f32_16x16x32_bf16 v[116:119], v[64:67], v[16:19], 0
    ds_read_b64_tr_b16 v[54:55], v8 offset:18432
    buffer_load_dwordx4 v5, s[28:31], s49 offen offset:1024 lds
    s_mul_i32 s49, s51, 1920
    v_mfma_f32_16x16x32_bf16 v[104:107], v[60:63], v[20:23], 0
    ds_read_b128 v[32:35], v11 offset:0
    s_add_u32 s56, s51, 81920
    v_mfma_f32_16x16x32_bf16 v[120:123], v[64:67], v[20:23], 0
    ds_read_b64_tr_b16 v[56:57], v147 offset:16384
    ds_read_b64_tr_b16 v[58:59], v147 offset:18432
    s_add_u32 s55, s58, s50
    v_mfma_f32_16x16x32_bf16 v[108:111], v[60:63], v[24:27], 0
    ds_read_b128 v[36:39], v11 offset:2048
    v_mfma_f32_16x16x32_bf16 v[124:127], v[64:67], v[24:27], 0
    ds_read_b128 v[40:43], v11 offset:4096
    v_mfma_f32_16x16x32_bf16 v[112:115], v[60:63], v[28:31], 0
    ds_read_b128 v[44:47], v11 offset:6144
    ds_read_b128 v[48:51], v14
    v_mfma_f32_16x16x32_bf16 v[128:131], v[64:67], v[28:31], 0
    s_cmp_ge_u32 s46, 2
    s_cbranch_scc1 QH3
    s_add_u32 m0, s59, s50
    s_nop 0
    buffer_load_dwordx4 v6, s[24:27], s51 offen lds
QH3:
    s_mov_b32 m0, s55
    s_nop 0
    buffer_load_dwordx4 v2, s[24:27], s51 offen lds
    s_waitcnt lgkmcnt(4)
    v_mfma_f32_16x16x32_bf16 v[68:71], v[52:55], v[32:35], v[68:71]
    ds_read_b64_tr_b16 v[60:61], v148 offset:16384
    s_mov_b32 m0, s48
    s_nop 0
    buffer_load_dwordx4 v4, s[28:31], s49 offen offset:0 lds
    v_mfma_f32_16x16x32_bf16 v[84:87], v[56:59], v[32:35], v[84:87]
    ds_read_b64_tr_b16 v[62:63], v148 offset:18432
    buffer_load_dwordx4 v5, s[28:31], s49 offen offset:1024 lds
    s_add_u32 s49, s49, 122880
    s_waitcnt lgkmcnt(5)
    v_mfma_f32_16x16x32_bf16 v[72:75], v[52:55], v[36:39], v[72:75]
    ds_read_b64_tr_b16 v[64:65], v149 offset:16384
    s_add_u32 s52, s52, 18432
    v_mfma_f32_16x16x32_bf16 v[88:91], v[56:59], v[36:39], v[88:91]
    ds_read_b64_tr_b16 v[66:67], v149 offset:18432
    s_cmp_eq_u32 s52, 55296
    s_cselect_b32 s52, 0, s52
    s_waitcnt lgkmcnt(6)
    v_mfma_f32_16x16x32_bf16 v[76:79], v[52:55], v[40:43], v[76:79]
    s_mov_b64 exec, s[62:63]
    ds_read_b128 v[64:67], v15 offset:64
    s_mov_b64 exec, -1
    v_mfma_f32_16x16x32_bf16 v[92:95], v[56:59], v[40:43], v[92:95]
    v_add_u32 v10, s52, v9
    v_add_u32 v13, s52, v12
    v_xor_b32 v8, 0x8000, v8
    s_waitcnt lgkmcnt(5)
    v_mfma_f32_16x16x32_bf16 v[80:83], v[52:55], v[44:47], v[80:83]
    v_xor_b32 v147, 0x8000, v147
    v_xor_b32 v148, 0x8000, v148
    v_mfma_f32_16x16x32_bf16 v[96:99], v[56:59], v[44:47], v[96:99]
    v_xor_b32 v149, 0x8000, v149
    v_add_u32 v15, 128, v15
    s_waitcnt lgkmcnt(4)
    s_cbranch_vccz QS5
    v_mfma_f32_16x16x32_bf16 v[132:135], v[52:55], v[48:51], v[132:135]
    v_mfma_f32_16x16x32_bf16 v[136:139], v[56:59], v[48:51], v[136:139]
QS5:
    s_waitcnt vmcnt(5) lgkmcnt(0)
    s_barrier
    v_mfma_f32_16x16x32_bf16 v[100:103], v[60:63], v[32:35], v[100:103]
    ds_read_b64_tr_b16 v[52:53], v8 offset:0
    s_add_u32 m0, s55, 8192
    v_mfma_f32_16x16x32_bf16 v[116:119], v[64:67], v[32:35], v[116:119]
    ds_read_b64_tr_b16 v[54:55], v8 offset:2048
    buffer_load_dwordx4 v2, s[24:27], s56 offen lds
    s_and_b32 s51, s68, 15
    v_mfma_f32_16x16x32_bf16 v[104:107], v[60:63], v[36:39], v[104:107]
    ds_read_b128 v[16:19], v10 offset:0
    s_lshl_b32 s51, s51, 7
    v_mfma_f32_16x16x32_bf16 v[120:123], v[64:67], v[36:39], v[120:123]
    ds_read_b64_tr_b16 v[56:57], v147 offset:0
    ds_read_b64_tr_b16 v[58:59], v147 offset:2048
    s_lshr_b64 s[68:69], s[68:69], 4
    v_mfma_f32_16x16x32_bf16 v[108:111], v[60:63], v[40:43], v[108:111]
    ds_read_b128 v[20:23], v10 offset:2048
    s_add_u32 s50, s50, 18432
    v_mfma_f32_16x16x32_bf16 v[124:127], v[64:67], v[40:43], v[124:127]
    ds_read_b128 v[24:27], v10 offset:4096
    s_cmp_eq_u32 s50, 55296
    v_mfma_f32_16x16x32_bf16 v[112:115], v[60:63], v[44:47], v[112:115]
    ds_read_b128 v[28:31], v10 offset:6144
    ds_read_b128 v[48:51], v13
    s_cselect_b32 s50, 0, s50
    v_mfma_f32_16x16x32_bf16 v[128:131], v[64:67], v[44:47], v[128:131]
    s_xor_b32 s48, s48, 32768
    s_mov_b32 s47, 1
    s_branch Q_CHK
Q_LOOP:
    s_waitcnt lgkmcnt(4)
    v_mfma_f32_16x16x32_bf16 v[68:71], v[52:55], v[16:19], v[68:71]
    ds_read_b64_tr_b16 v[60:61], v148 offset:0
    s_xor_b32 m0, s48, 49152
    v_mfma_f32_16x16x32_bf16 v[84:87], v[56:59], v[16:19], v[84:87]
    ds_read_b64_tr_b16 v[62:63], v148 offset:2048
    buffer_load_dwordx4 v4, s[28:31], s49 offen offset:0 lds
    s_waitcnt lgkmcnt(5)
    v_mfma_f32_16x16x32_bf16 v[72:75], v[52:55], v[20:23], v[72:75]
    ds_read_b64_tr_b16 v[64:65], v149 offset:0
    buffer_load_dwordx4 v5, s[28:31], s49 offen offset:1024 lds
    v_mfma_f32_16x16x32_bf16 v[88:91], v[56:59], v[20:23], v[88:91]
    ds_read_b64_tr_b16 v[66:67], v149 offset:2048
    s_mul_i32 s49, s51, 1920
    s_waitcnt lgkmcnt(6)
    v_mfma_f32_16x16x32_bf16 v[76:79], v[52:55], v[24:27], v[76:79]
    s_mov_b64 exec, s[62:63]
    ds_read_b128 v[64:67], v15 offset:0
    s_mov_b64 exec, -1
    v_mfma_f32_16x16x32_bf16 v[92:95], v[56:59], v[24:27], v[92:95]
    s_waitcnt lgkmcnt(5)
    v_mfma_f32_16x16x32_bf16 v[80:83], v[52:55], v[28:31], v[80:83]
    s_add_u32 s56, s51, 81920
    s_add_u32 s55, s58, s50
    v_mfma_f32_16x16x32_bf16 v[96:99], v[56:59], v[28:31], v[96:99]
    v_xor_b32 v11, 64, v10
    v_xor_b32 v14, 64, v13
    s_waitcnt lgkmcnt(4)
    s_cbranch_vccz QS7
    v_mfma_f32_16x16x32_bf16 v[132:135], v[52:55], v[48:51], v[132:135]
    v_mfma_f32_16x16x32_bf16 v[136:139], v[56:59], v[48:51], v[136:139]
QS7:
    s_waitcnt vmcnt(5) lgkmcnt(0)
    s_barrier
    v_mfma_f32_16x16x32_bf16 v[100:103], v[60:63], v[16:19], v[100:103]
    ds_read_b64_tr_b16 v[52:53], v8 offset:16384
    v_mfma_f32_16x16x32_bf16 v[116:119], v[64:67], v[16:19], v[116:119]
    ds_read_b64_tr_b16 v[54:55], v8 offset:18432
    v_mfma_f32_16x16x32_bf16 v[104:107], v[60:63], v[20:23], v[104:107]
    ds_read_b128 v[32:35], v11 offset:0
    v_mfma_f32_16x16x32_bf16 v[120:123], v[64:67], v[20:23], v[120:123]
    ds_read_b64_tr_b16 v[56:57], v147 offset:16384
    ds_read_b64_tr_b16 v[58:59], v147 offset:18432
    v_mfma_f32_16x16x32_bf16 v[108:111], v[60:63], v[24:27], v[108:111]
    ds_read_b128 v[36:39], v11 offset:2048
    v_mfma_f32_16x16x32_bf16 v[124:127], v[64:67], v[24:27], v[124:127]
    ds_read_b128 v[40:43], v11 offset:4096
    s_cmp_ge_u32 s46, 2
    s_cbranch_scc1 QH6
    s_add_u32 m0, s59, s50
    s_nop 0
    buffer_load_dwordx4 v6, s[24:27], s51 offen lds
QH6:
    v_mfma_f32_16x16x32_bf16 v[112:115], v[60:63], v[28:31], v[112:115]
    ds_read_b128 v[44:47], v11 offset:6144
    ds_read_b128 v[48:51], v14
    v_mfma_f32_16x16x32_bf16 v[128:131], v[64:67], v[28:31], v[128:131]
    s_mov_b32 m0, s55
    s_nop 0
    buffer_load_dwordx4 v2, s[24:27], s51 offen lds
    s_waitcnt lgkmcnt(4)
    v_mfma_f32_16x16x32_bf16 v[68:71], v[52:55], v[32:35], v[68:71]
    ds_read_b64_tr_b16 v[60:61], v148 offset:16384
    s_mov_b32 m0, s48
    s_nop 0
    buffer_load_dwordx4 v4, s[28:31], s49 offen offset:0 lds
    v_mfma_f32_16x16x32_bf16 v[84:87], v[56:59], v[32:35], v[84:87]
    ds_read_b64_tr_b16 v[62:63], v148 offset:18432
    buffer_load_dwordx4 v5, s[28:31], s49 offen offset:1024 lds
    s_add_u32 s49, s49, 122880
    s_waitcnt lgkmcnt(5)
    v_mfma_f32_16x16x32_bf16 v[72:75], v[52:55], v[36:39], v[72:75]
    ds_read_b64_tr_b16 v[64:65], v149 offset:16384
    s_add_u32 s52, s52, 18432
    v_mfma_f32_16x16x32_bf16 v[88:91], v[56:59], v[36:39], v[88:91]
    ds_read_b64_tr_b16 v[66:67], v149 offset:18432
    s_cmp_eq_u32 s52, 55296
    s_cselect_b32 s52, 0, s52
    s_waitcnt lgkmcnt(6)
    v_mfma_f32_16x16x32_bf16 v[76:79], v[52:55], v[40:43], v[76:79]
    s_mov_b64 exec, s[62:63]
    ds_read_b128 v[64:67], v15 offset:64
    s_mov_b64 exec, -1
    v_mfma_f32_16x16x32_bf16 v[92:95], v[56:59], v[40:43], v[92:95]
    v_add_u32 v10, s52, v9
    v_add_u32 v13, s52, v12
    v_xor_b32 v8, 0x8000, v8
    s_waitcnt lgkmcnt(5)
    v_mfma_f32_16x16x32_bf16 v[80:83], v[52:55], v[44:47], v[80:83]
    v_xor_b32 v147, 0x8000, v147
    v_xor_b32 v148, 0x8000, v148
    v_mfma_f32_16x16x32_bf16 v[96:99], v[56:59], v[44:47], v[96:99]
    v_xor_b32 v149, 0x8000, v149
    v_add_u32 v15, 128, v15
    s_waitcnt lgkmcnt(4)
    s_cbranch_vccz QS8
    v_mfma_f32_16x16x32_bf16 v[132:135], v[52:55], v[48:51], v[132:135]
    v_mfma_f32_16x16x32_bf16 v[136:139], v[56:59], v[48:51], v[136:139]
QS8:
    s_waitcnt vmcnt(5) lgkmcnt(0)
    s_barrier
    v_mfma_f32_16x16x32_bf16 v[100:103], v[60:63], v[32:35], v[100:103]
    ds_read_b64_tr_b16 v[52:53], v8 offset:0
    s_add_u32 m0, s55, 8192
    v_mfma_f32_16x16x32_bf16 v[116:119], v[64:67], v[32:35], v[116:119]
    ds_read_b64_tr_b16 v[54:55], v8 offset:2048
    buffer_load_dwordx4 v2, s[24:27], s56 offen lds
    s_and_b32 s51, s68, 15
    v_mfma_f32_16x16x32_bf16 v[104:107], v[60:63], v[36:39], v[104:107]
    ds_read_b128 v[16:19], v10 offset:0
    s_lshl_b32 s51, s51, 7
    v_mfma_f32_16x16x32_bf16 v[120:123], v[64:67], v[36:39], v[120:123]
    ds_read_b64_tr_b16 v[56:57], v147 offset:0
    ds_read_b64_tr_b16 v[58:59], v147 offset:2048
    s_lshr_b64 s[68:69], s[68:69], 4
    v_mfma_f32_16x16x32_bf16 v[108:111], v[60:63], v[40:43], v[108:111]
    ds_read_b128 v[20:23], v10 offset:2048
    s_add_u32 s50, s50, 18432
    v_mfma_f32_16x16x32_bf16 v[124:127], v[64:67], v[40:43], v[124:127]
    ds_read_b128 v[24:27], v10 offset:4096
    s_cmp_eq_u32 s50, 55296
    v_mfma_f32_16x16x32_bf16 v[112:115], v[60:63], v[44:47], v[112:115]
    ds_read_b128 v[28:31], v10 offset:6144
    ds_read_b128 v[48:51], v13
    s_cselect_b32 s50, 0, s50
    v_mfma_f32_16x16x32_bf16 v[128:131], v[64:67], v[44:47], v[128:131]
    s_xor_b32 s48, s48, 32768
    s_add_u32 s47, s47, 1
Q_CHK:
    s_bitcmp1_b32 s60, s47
    s_cbranch_scc1 Q_SIDE
Q_BACK:
    s_cmp_lt_u32 s47, 8
    s_cbranch_scc1 Q_LOOP
    s_waitcnt lgkmcnt(4)
    v_mfma_f32_16x16x32_bf16 v[68:71], v[52:55], v[16:19], v[68:71]
    ds_read_b64_tr_b16 v[60:61], v148 offset:0
    s_xor_b32 m0, s48, 49152
    v_mfma_f32_16x16x32_bf16 v[84:87], v[56:59], v[16:19], v[84:87]
    ds_read_b64_tr_b16 v[62:63], v148 offset:2048
    s_waitcnt lgkmcnt(5)
    v_mfma_f32_16x16x32_bf16 v[72:75], v[52:55], v[20:23], v[72:75]
    ds_read_b64_tr_b16 v[64:65], v149 offset:0
    buffer_load_dwordx4 v4, s[28:31], s49 offen offset:0 lds
    v_mfma_f32_16x16x32_bf16 v[88:91], v[56:59], v[20:23], v[88:91]
    ds_read_b64_tr_b16 v[66:67], v149 offset:2048
    s_waitcnt lgkmcnt(6)
    v_mfma_f32_16x16x32_bf16 v[76:79], v[52:55], v[24:27], v[76:79]
    s_mov_b64 exec, s[62:63]
    ds_read_b128 v[64:67], v15 offset:0
    s_mov_b64 exec, -1
    v_mfma_f32_16x16x32_bf16 v[92:95], v[56:59], v[24:27], v[92:95]
    s_waitcnt lgkmcnt(5)
    v_mfma_f32_16x16x32_bf16 v[80:83], v[52:55], v[28:31], v[80:83]
    buffer_load_dwordx4 v5, s[28:31], s49 offen offset:1024 lds
    v_xor_b32 v11, 64, v10
    v_mfma_f32_16x16x32_bf16 v[96:99], v[56:59], v[28:31], v[96:99]
    v_xor_b32 v14, 64, v13
    s_waitcnt lgkmcnt(4)
    s_cbranch_vccz QS9
    v_mfma_f32_16x16x32_bf16 v[132:135], v[52:55], v[48:51], v[132:135]
    v_mfma_f32_16x16x32_bf16 v[136:139], v[56:59], v[48:51], v[136:139]
QS9:
    s_cmp_lg_u32 s46, 3
    s_cbranch_scc1 Q_W2OK
    s_mov_b32 s55, 20000
Q_W2CHK:
    v_cmp_ne_u32 s[40:41], s10, v156
    v_cmp_ne_u32 s[42:43], s10, v157
    s_nop 1
    s_or_b64 s[40:41], s[40:41], s[42:43]
    s_cbranch_scc0 Q_W2OK
    s_sub_u32 s55, s55, 1
    s_cmp_eq_u32 s55, 0
    s_cbranch_scc1 Q_W2OK
    s_sleep 8
    v_lshlrev_b32 v154, 3, v0
    s_mov_b32 s54, 12603392
    buffer_load_dwordx2 v[156:157], v154, s[32:35], s54 offen sc1
    s_waitcnt vmcnt(0)
    s_branch Q_W2CHK
Q_W2OK:
    s_waitcnt vmcnt(5) lgkmcnt(0)
    s_barrier
    v_mfma_f32_16x16x32_bf16 v[100:103], v[60:63], v[16:19], v[100:103]
    ds_read_b64_tr_b16 v[52:53], v8 offset:16384
    buffer_load_dwordx4 v[156:159], v152, s[32:35], s76 offen offset:0 sc1
    v_mfma_f32_16x16x32_bf16 v[116:119], v[64:67], v[16:19], v[116:119]
    ds_read_b64_tr_b16 v[54:55], v8 offset:18432
    v_mfma_f32_16x16x32_bf16 v[104:107], v[60:63], v[20:23], v[104:107]
    ds_read_b128 v[32:35], v11 offset:0
    buffer_load_dwordx4 v[160:163], v152, s[32:35], s76 offen offset:1024 sc1
    v_mfma_f32_16x16x32_bf16 v[120:123], v[64:67], v[20:23], v[120:123]
    ds_read_b64_tr_b16 v[56:57], v147 offset:16384
    ds_read_b64_tr_b16 v[58:59], v147 offset:18432
    v_mfma_f32_16x16x32_bf16 v[108:111], v[60:63], v[24:27], v[108:111]
    ds_read_b128 v[36:39], v11 offset:2048
    v_mfma_f32_16x16x32_bf16 v[124:127], v[64:67], v[24:27], v[124:127]
    ds_read_b128 v[40:43], v11 offset:4096
    v_mfma_f32_16x16x32_bf16 v[112:115], v[60:63], v[28:31], v[112:115]
    ds_read_b128 v[44:47], v11 offset:6144
    ds_read_b128 v[48:51], v14
    v_mfma_f32_16x16x32_bf16 v[128:131], v[64:67], v[28:31], v[128:131]
    buffer_load_dwordx4 v[164:167], v152, s[32:35], s76 offen offset:2048 sc1
    s_waitcnt lgkmcnt(4)
    v_mfma_f32_16x16x32_bf16 v[68:71], v[52:55], v[32:35], v[68:71]
    ds_read_b64_tr_b16 v[60:61], v148 offset:16384
    buffer_load_dwordx4 v[168:171], v152, s[32:35], s76 offen offset:3072 sc1
    buffer_load_dwordx4 v[172:175], v153, s[32:35], s76 offen offset:0 sc1
    v_mfma_f32_16x16x32_bf16 v[84:87], v[56:59], v[32:35], v[84:87]
    ds_read_b64_tr_b16 v[62:63], v148 offset:18432
    s_add_u32 s76, s76, 5120
    buffer_load_dwordx4 v[176:179], v152, s[32:35], s76 offen offset:0 sc1
    s_waitcnt lgkmcnt(5)
    v_mfma_f32_16x16x32_bf16 v[72:75], v[52:55], v[36:39], v[72:75]
    ds_read_b64_tr_b16 v[64:65], v149 offset:16384
    s_add_u32 s52, s52, 18432
    v_mfma_f32_16x16x32_bf16 v[88:91], v[56:59], v[36:39], v[88:91]
    ds_read_b64_tr_b16 v[66:67], v149 offset:18432
    s_cmp_eq_u32 s52, 55296
    s_cselect_b32 s52, 0, s52
    s_waitcnt lgkmcnt(6)
    v_mfma_f32_16x16x32_bf16 v[76:79], v[52:55], v[40:43], v[76:79]
    s_mov_b64 exec, s[62:63]
    ds_read_b128 v[64:67], v15 offset:64
    s_mov_b64 exec, -1
    v_mfma_f32_16x16x32_bf16 v[92:95], v[56:59], v[40:43], v[92:95]
    v_add_u32 v10, s52, v9
    v_add_u32 v13, s52, v12
    v_xor_b32 v8, 0x8000, v8
    s_waitcnt lgkmcnt(5)
    v_mfma_f32_16x16x32_bf16 v[80:83], v[52:55], v[44:47], v[80:83]
    v_xor_b32 v147, 0x8000, v147
    v_xor_b32 v148, 0x8000, v148
    v_mfma_f32_16x16x32_bf16 v[96:99], v[56:59], v[44:47], v[96:99]
    v_xor_b32 v149, 0x8000, v149
    v_add_u32 v15, 128, v15
    s_waitcnt lgkmcnt(4)
    s_cbranch_vccz QS10
    v_mfma_f32_16x16x32_bf16 v[132:135], v[52:55], v[48:51], v[132:135]
    v_mfma_f32_16x16x32_bf16 v[136:139], v[56:59], v[48:51], v[136:139]
QS10:
    s_waitcnt vmcnt(6) lgkmcnt(0)
    s_barrier
    v_mfma_f32_16x16x32_bf16 v[100:103], v[60:63], v[32:35], v[100:103]
    ds_read_b64_tr_b16 v[52:53], v8 offset:0
    buffer_load_dwordx4 v[180:183], v152, s[32:35], s76 offen offset:1024 sc1
    buffer_load_dwordx4 v[184:187], v152, s[32:35], s76 offen offset:2048 sc1
    v_mfma_f32_16x16x32_bf16 v[116:119], v[64:67], v[32:35], v[116:119]
    ds_read_b64_tr_b16 v[54:55], v8 offset:2048
    buffer_load_dwordx4 v[188:191], v152, s[32:35], s76 offen offset:3072 sc1
    s_bfe_u32 s54, s46, 0x10001
    v_mfma_f32_16x16x32_bf16 v[104:107], v[60:63], v[36:39], v[104:107]
    ds_read_b128 v[16:19], v10 offset:0
    s_mul_i32 s56, s54, 72
    s_lshr_b32 s54, s46, 2
    v_mfma_f32_16x16x32_bf16 v[120:123], v[64:67], v[36:39], v[120:123]
    ds_read_b64_tr_b16 v[56:57], v147 offset:0
    ds_read_b64_tr_b16 v[58:59], v147 offset:2048
    s_lshl_b32 s54, s54, 5
    s_add_u32 s56, s56, s54
    v_mfma_f32_16x16x32_bf16 v[108:111], v[60:63], v[40:43], v[108:111]
    ds_read_b128 v[20:23], v10 offset:2048
    s_mul_i32 s56, s56, 488
    v_mul_u32_u24 v142, 488, v1
    v_mfma_f32_16x16x32_bf16 v[124:127], v[64:67], v[40:43], v[124:127]
    ds_read_b128 v[24:27], v10 offset:4096
    v_add_u32 v142, s56, v142
    s_and_b32 s54, s46, 1
    v_mfma_f32_16x16x32_bf16 v[112:115], v[60:63], v[44:47], v[112:115]
    ds_read_b128 v[28:31], v10 offset:6144
    ds_read_b128 v[48:51], v13
    s_mul_i32 s54, s54, 80
    v_mfma_f32_16x16x32_bf16 v[128:131], v[64:67], v[44:47], v[128:131]
    v_mul_u32_u24 v4, 40, v3
    v_add_u32 v4, s54, v4
    v_add_u32 v140, v142, v4
    s_waitcnt lgkmcnt(4)
    v_mfma_f32_16x16x32_bf16 v[68:71], v[52:55], v[16:19], v[68:71]
    ds_read_b64_tr_b16 v[60:61], v148 offset:0
    buffer_load_dwordx4 v[192:195], v153, s[32:35], s76 offen offset:0 sc1
    s_add_u32 s76, s76, 5120
    v_mfma_f32_16x16x32_bf16 v[84:87], v[56:59], v[16:19], v[84:87]
    ds_read_b64_tr_b16 v[62:63], v148 offset:2048
    buffer_load_dwordx4 v[196:199], v152, s[32:35], s76 offen offset:0 sc1
    buffer_load_dwordx4 v[200:203], v152, s[32:35], s76 offen offset:1024 sc1
    s_waitcnt lgkmcnt(5)
    v_mfma_f32_16x16x32_bf16 v[72:75], v[52:55], v[20:23], v[72:75]
    ds_read_b64_tr_b16 v[64:65], v149 offset:0
    v_and_b32 v5, 16, v0
    v_and_b32 v7, 3, v0
    v_mfma_f32_16x16x32_bf16 v[88:91], v[56:59], v[20:23], v[88:91]
    ds_read_b64_tr_b16 v[66:67], v149 offset:2048
    v_lshl_add_u32 v5, v7, 2, v5
    v_bfe_u32 v6, v0, 2, 2
    s_waitcnt lgkmcnt(6)
    v_mfma_f32_16x16x32_bf16 v[76:79], v[52:55], v[24:27], v[76:79]
    s_mov_b64 exec, s[62:63]
    ds_read_b128 v[64:67], v15 offset:0
    s_mov_b64 exec, -1
    v_mfma_f32_16x16x32_bf16 v[92:95], v[56:59], v[24:27], v[92:95]
    v_add_u32 v5, v5, v6
    v_mul_u32_u24 v5, 488, v5
    s_waitcnt lgkmcnt(5)
    v_mfma_f32_16x16x32_bf16 v[80:83], v[52:55], v[28:31], v[80:83]
    s_add_u32 s56, s56, 160
    v_add3_u32 v141, v5, v4, s56
    v_lshlrev_b32 v146, 4, v1
    v_mfma_f32_16x16x32_bf16 v[96:99], v[56:59], v[28:31], v[96:99]
    v_lshl_add_u32 v143, v3, 10, v146
    v_xor_b32 v11, 64, v10
    v_xor_b32 v14, 64, v13
    s_waitcnt lgkmcnt(4)
    s_cbranch_vccz QS11
    v_mfma_f32_16x16x32_bf16 v[132:135], v[52:55], v[48:51], v[132:135]
    v_mfma_f32_16x16x32_bf16 v[136:139], v[56:59], v[48:51], v[136:139]
QS11:
    v_mfma_f32_16x16x32_bf16 v[100:103], v[60:63], v[16:19], v[100:103]
    ds_read_b64_tr_b16 v[52:53], v8 offset:16384
    buffer_load_dwordx4 v[204:207], v152, s[32:35], s76 offen offset:2048 sc1
    buffer_load_dwordx4 v[208:211], v152, s[32:35], s76 offen offset:3072 sc1
    v_mfma_f32_16x16x32_bf16 v[116:119], v[64:67], v[16:19], v[116:119]
    ds_read_b64_tr_b16 v[54:55], v8 offset:18432
    buffer_load_dwordx4 v[212:215], v153, s[32:35], s76 offen offset:0 sc1
    v_mfma_f32_16x16x32_bf16 v[104:107], v[60:63], v[20:23], v[104:107]
    ds_read_b128 v[32:35], v11 offset:0
    s_add_u32 s76, s76, 5120
    v_mov_b32 v5, 0xffff
    v_mfma_f32_16x16x32_bf16 v[120:123], v[64:67], v[20:23], v[120:123]
    ds_read_b64_tr_b16 v[56:57], v147 offset:16384
    ds_read_b64_tr_b16 v[58:59], v147 offset:18432
    v_mov_b32 v6, -1
    v_mfma_f32_16x16x32_bf16 v[108:111], v[60:63], v[24:27], v[108:111]
    ds_read_b128 v[36:39], v11 offset:2048
    v_cmp_le_u32 s[40:41], 1, v7
    v_mfma_f32_16x16x32_bf16 v[124:127], v[64:67], v[24:27], v[124:127]
    ds_read_b128 v[40:43], v11 offset:4096
    v_cmp_le_u32 s[42:43], 2, v7
    v_cmp_le_u32 s[36:37], 3, v7
    v_mfma_f32_16x16x32_bf16 v[112:115], v[60:63], v[28:31], v[112:115]
    ds_read_b128 v[44:47], v11 offset:6144
    ds_read_b128 v[48:51], v14
    v_mfma_f32_16x16x32_bf16 v[128:131], v[64:67], v[28:31], v[128:131]
    v_cndmask_b32 v144, v5, v6, s[40:41]
    v_cndmask_b32 v145, 0, v5, s[42:43]
    v_cndmask_b32 v145, v145, v6, s[36:37]
    s_waitcnt lgkmcnt(4)
    v_mfma_f32_16x16x32_bf16 v[68:71], v[52:55], v[32:35], v[68:71]
    ds_read_b64_tr_b16 v[60:61], v148 offset:16384
    buffer_load_dwordx4 v[216:219], v152, s[32:35], s76 offen offset:0 sc1
    buffer_load_dwordx4 v[220:223], v152, s[32:35], s76 offen offset:1024 sc1
    v_mfma_f32_16x16x32_bf16 v[84:87], v[56:59], v[32:35], v[84:87]
    ds_read_b64_tr_b16 v[62:63], v148 offset:18432
    buffer_load_dwordx4 v[224:227], v152, s[32:35], s76 offen offset:2048 sc1
    s_and_b32 s56, s46, 1
    s_waitcnt lgkmcnt(5)
    v_mfma_f32_16x16x32_bf16 v[72:75], v[52:55], v[36:39], v[72:75]
    ds_read_b64_tr_b16 v[64:65], v149 offset:16384
    s_lshl_b32 s56, s56, 5
    s_add_u32 s56, s56, 8
    v_mfma_f32_16x16x32_bf16 v[88:91], v[56:59], v[36:39], v[88:91]
    ds_read_b64_tr_b16 v[66:67], v149 offset:18432
    v_and_b32 v22, 15, v0
    v_add_u32 v21, s56, v22
    s_waitcnt lgkmcnt(6)
    v_mfma_f32_16x16x32_bf16 v[76:79], v[52:55], v[40:43], v[76:79]
    s_mov_b64 exec, s[62:63]
    ds_read_b128 v[64:67], v15 offset:64
    s_mov_b64 exec, -1
    v_mfma_f32_16x16x32_bf16 v[92:95], v[56:59], v[40:43], v[92:95]
    v_mul_u32_u24 v21, 488, v21
    v_bfe_u32 v22, v0, 3, 1
    s_waitcnt lgkmcnt(5)
    v_mfma_f32_16x16x32_bf16 v[80:83], v[52:55], v[44:47], v[80:83]
    v_mul_u32_u24 v22, 72, v22
    v_and_b32 v23, 7, v0
    v_add_u32 v22, v22, v23
    v_mfma_f32_16x16x32_bf16 v[96:99], v[56:59], v[44:47], v[96:99]
    v_mul_u32_u24 v22, 488, v22
    v_sub_u32 v20, v21, v22
    v_lshrrev_b32 v23, 4, v0
    s_waitcnt lgkmcnt(4)
    s_cbranch_vccz QS12
    v_mfma_f32_16x16x32_bf16 v[132:135], v[52:55], v[48:51], v[132:135]
    v_mfma_f32_16x16x32_bf16 v[136:139], v[56:59], v[48:51], v[136:139]
QS12:
    s_waitcnt lgkmcnt(0)
    s_barrier
    v_mfma_f32_16x16x32_bf16 v[100:103], v[60:63], v[32:35], v[100:103]
    s_xor_b32 s56, s11, 0
    v_lshl_add_u32 v22, s56, 2, v23
    v_mfma_f32_16x16x32_bf16 v[116:119], v[64:67], v[32:35], v[116:119]
    v_min_u32 v22, 60, v22
    v_lshl_add_u32 v16, v22, 3, v21
    s_xor_b32 s56, s11, 1
    v_mfma_f32_16x16x32_bf16 v[104:107], v[60:63], v[36:39], v[104:107]
    v_lshl_add_u32 v22, s56, 2, v23
    v_min_u32 v22, 60, v22
    v_mfma_f32_16x16x32_bf16 v[120:123], v[64:67], v[36:39], v[120:123]
    v_lshl_add_u32 v17, v22, 3, v21
    s_xor_b32 s56, s11, 2
    v_lshl_add_u32 v22, s56, 2, v23
    v_mfma_f32_16x16x32_bf16 v[108:111], v[60:63], v[40:43], v[108:111]
    v_min_u32 v22, 60, v22
    v_lshl_add_u32 v18, v22, 3, v21
    v_mfma_f32_16x16x32_bf16 v[124:127], v[64:67], v[40:43], v[124:127]
    s_xor_b32 s56, s11, 3
    v_lshl_add_u32 v22, s56, 2, v23
    v_mfma_f32_16x16x32_bf16 v[112:115], v[60:63], v[44:47], v[112:115]
    v_min_u32 v22, 60, v22
    v_lshl_add_u32 v19, v22, 3, v21
    buffer_load_dwordx4 v[228:231], v152, s[32:35], s76 offen offset:3072 sc1
    v_mfma_f32_16x16x32_bf16 v[128:131], v[64:67], v[44:47], v[128:131]
    buffer_load_dwordx4 v[232:235], v153, s[32:35], s76 offen offset:0 sc1
    s_add_u32 s76, s76, 5120
    s_setprio 0
    v_cvt_pk_bf16_f32 v24, v68, v69
    v_cvt_pk_bf16_f32 v25, v70, v71
    ds_write_b64 v16, v[24:25] offset:0
    v_cvt_pk_bf16_f32 v26, v72, v73
    v_cvt_pk_bf16_f32 v27, v74, v75
    ds_write_b64 v16, v[26:27] offset:7808
    v_cvt_pk_bf16_f32 v28, v76, v77
    v_cvt_pk_bf16_f32 v29, v78, v79
    ds_write_b64 v16, v[28:29] offset:35136
    v_cvt_pk_bf16_f32 v30, v80, v81
    v_cvt_pk_bf16_f32 v31, v82, v83
    ds_write_b64 v16, v[30:31] offset:42944
    buffer_load_dwordx4 v[236:239], v152, s[32:35], s76 offen offset:0 sc1
    v_cvt_pk_bf16_f32 v24, v84, v85
    v_cvt_pk_bf16_f32 v25, v86, v87
    ds_write_b64 v17, v[24:25] offset:0
    v_cvt_pk_bf16_f32 v26, v88, v89
    v_cvt_pk_bf16_f32 v27, v90, v91
    ds_write_b64 v17, v[26:27] offset:7808
    v_cvt_pk_bf16_f32 v28, v92, v93
    v_cvt_pk_bf16_f32 v29, v94, v95
    ds_write_b64 v17, v[28:29] offset:35136
    v_cvt_pk_bf16_f32 v30, v96, v97
    v_cvt_pk_bf16_f32 v31, v98, v99
    ds_write_b64 v17, v[30:31] offset:42944
    buffer_load_dwordx4 v[240:243], v152, s[32:35], s76 offen offset:1024 sc1
    v_cvt_pk_bf16_f32 v24, v100, v101
    v_cvt_pk_bf16_f32 v25, v102, v103
    ds_write_b64 v18, v[24:25] offset:0
    v_cvt_pk_bf16_f32 v26, v104, v105
    v_cvt_pk_bf16_f32 v27, v106, v107
    ds_write_b64 v18, v[26:27] offset:7808
    v_cvt_pk_bf16_f32 v28, v108, v109
    v_cvt_pk_bf16_f32 v29, v110, v111
    ds_write_b64 v18, v[28:29] offset:35136
    v_cvt_pk_bf16_f32 v30, v112, v113
    v_cvt_pk_bf16_f32 v31, v114, v115
    ds_write_b64 v18, v[30:31] offset:42944
    buffer_load_dwordx4 v[244:247], v152, s[32:35], s76 offen offset:2048 sc1
    v_cvt_pk_bf16_f32 v24, v116, v117
    v_cvt_pk_bf16_f32 v25, v118, v119
    ds_write_b64 v19, v[24:25] offset:0
    v_cvt_pk_bf16_f32 v26, v120, v121
    v_cvt_pk_bf16_f32 v27, v122, v123
    ds_write_b64 v19, v[26:27] offset:7808
    v_cvt_pk_bf16_f32 v28, v124, v125
    v_cvt_pk_bf16_f32 v29, v126, v127
    ds_write_b64 v19, v[28:29] offset:35136
    v_cvt_pk_bf16_f32 v30, v128, v129
    v_cvt_pk_bf16_f32 v31, v130, v131
    ds_write_b64 v19, v[30:31] offset:42944
    buffer_load_dwordx4 v[248:251], v152, s[32:35], s76 offen offset:3072 sc1
    s_cbranch_vccz Q_NOH
    v_sub_u32 v16, v16, v20
    v_sub_u32 v17, v17, v20
    v_cvt_pk_bf16_f32 v24, v132, v133
    v_cvt_pk_bf16_f32 v25, v134, v135
    ds_write_b64 v16, v[24:25] offset:0
    v_cvt_pk_bf16_f32 v26, v136, v137
    v_cvt_pk_bf16_f32 v27, v138, v139
    ds_write_b64 v17, v[26:27] offset:0
Q_NOH:
    s_cmp_lg_u32 s11, 12
    s_cbranch_scc1 Q_NOG
    s_mov_b32 s62, 0x3fb8aa3b
    v_mov_b32 v44, 0x42a00000
    s_lshl_b32 s56, s44, 1
    s_and_b32 s55, s46, 1
    s_add_u32 s56, s56, s55
    s_lshl_b32 s56, s56, 8
    s_add_u32 s56, s56, 12582912
    v_lshlrev_b32 v22, 2, v0
    v_mul_f32 v40, s62, v116
    v_mul_f32 v41, s62, v120
    v_mul_f32 v42, s62, v124
    v_mul_f32 v43, s62, v128
    v_med3_f32 v40, v40, -v44, v44
    v_med3_f32 v41, v41, -v44, v44
    v_med3_f32 v42, v42, -v44, v44
    v_med3_f32 v43, v43, -v44, v44
    v_exp_f32 v40, v40
    v_exp_f32 v41, v41
    v_exp_f32 v42, v42
    v_exp_f32 v43, v43
    s_nop 0
    ds_write_b32 v21, v40 offset:480
    ds_write_b32 v21, v41 offset:8288
    ds_write_b32 v21, v42 offset:35616
    ds_write_b32 v21, v43 offset:43424
    s_cmp_lg_u32 s45, 0
    s_cbranch_scc1 Q_NOG
    v_cmp_eq_u32 vcc, 1, v23
    s_nop 1
    v_cndmask_b32 v40, v40, v41, vcc
    v_cmp_eq_u32 vcc, 2, v23
    s_nop 1
    v_cndmask_b32 v40, v40, v42, vcc
    v_cmp_eq_u32 vcc, 3, v23
    s_nop 1
    v_cndmask_b32 v40, v40, v43, vcc
    v_add_f32 v44, 1.0, v40
    v_rcp_f32 v44, v44
    s_nop 0
    buffer_store_dword v44, v22, s[32:35], s56 offen sc1
Q_NOG:
    s_mov_b32 s62, 0x3ea52b5c
    s_mov_b32 s63, s62
    s_waitcnt lgkmcnt(0)
    s_barrier
    ds_read_b64 v[16:17], v140 offset:4224
    ds_read_b64 v[28:29], v140 offset:3904
    ds_read_b64 v[38:39], v140 offset:1952
    ds_read_b64 v[48:49], v140 offset:0
    ds_read_b64 v[18:19], v140 offset:4232
    ds_read_b64 v[30:31], v140 offset:3912
    ds_read_b64 v[40:41], v140 offset:1960
    ds_read_b64 v[50:51], v140 offset:8
    ds_read_b64 v[20:21], v140 offset:4240
    ds_read_b64 v[32:33], v140 offset:3920
    ds_read_b64 v[42:43], v140 offset:1968
    ds_read_b64 v[52:53], v140 offset:16
    s_waitcnt lgkmcnt(8)
    v_mfma_f32_4x4x4_16b_bf16 v[88:91], v[28:29], v[16:17], 0
    v_mfma_f32_4x4x4_16b_bf16 v[92:95], v[38:39], v[16:17], 0
    v_mfma_f32_4x4x4_16b_bf16 v[96:99], v[48:49], v[16:17], 0
    ds_read_b64 v[22:23], v140 offset:4248
    ds_read_b64 v[34:35], v140 offset:3928
    ds_read_b64 v[44:45], v140 offset:1976
    ds_read_b64 v[54:55], v140 offset:24
    s_waitcnt lgkmcnt(8)
    v_mfma_f32_4x4x4_16b_bf16 v[88:91], v[30:31], v[18:19], v[88:91]
    v_mfma_f32_4x4x4_16b_bf16 v[92:95], v[40:41], v[18:19], v[92:95]
    v_mfma_f32_4x4x4_16b_bf16 v[96:99], v[50:51], v[18:19], v[96:99]
    ds_read_b64 v[24:25], v140 offset:4256
    ds_read_b64 v[36:37], v140 offset:3936
    ds_read_b64 v[46:47], v140 offset:1984
    ds_read_b64 v[56:57], v140 offset:32
    s_waitcnt lgkmcnt(8)
    v_mfma_f32_4x4x4_16b_bf16 v[88:91], v[32:33], v[20:21], v[88:91]
    v_mfma_f32_4x4x4_16b_bf16 v[92:95], v[42:43], v[20:21], v[92:95]
    v_mfma_f32_4x4x4_16b_bf16 v[96:99], v[52:53], v[20:21], v[96:99]
    ds_read_b64_tr_b16 v[58:59], v141 offset:3904
    ds_read_b64_tr_b16 v[68:69], v141 offset:1952
    ds_read_b64_tr_b16 v[78:79], v141 offset:0
    ds_read_b64_tr_b16 v[60:61], v141 offset:3912
    s_waitcnt lgkmcnt(8)
    v_mfma_f32_4x4x4_16b_bf16 v[88:91], v[34:35], v[22:23], v[88:91]
    v_mfma_f32_4x4x4_16b_bf16 v[92:95], v[44:45], v[22:23], v[92:95]
    v_mfma_f32_4x4x4_16b_bf16 v[96:99], v[54:55], v[22:23], v[96:99]
    ds_read_b64_tr_b16 v[70:71], v141 offset:1960
    ds_read_b64_tr_b16 v[80:81], v141 offset:8
    ds_read_b64_tr_b16 v[62:63], v141 offset:3920
    ds_read_b64_tr_b16 v[72:73], v141 offset:1968
    s_waitcnt lgkmcnt(8)
    v_mfma_f32_4x4x4_16b_bf16 v[88:91], v[36:37], v[24:25], v[88:91]
    v_mfma_f32_4x4x4_16b_bf16 v[92:95], v[46:47], v[24:25], v[92:95]
    v_mfma_f32_4x4x4_16b_bf16 v[96:99], v[56:57], v[24:25], v[96:99]
    ds_read_b64_tr_b16 v[82:83], v141 offset:16
    ds_read_b64_tr_b16 v[64:65], v141 offset:3928
    ds_read_b64_tr_b16 v[74:75], v141 offset:1976
    ds_read_b64_tr_b16 v[84:85], v141 offset:24
    ds_read_b64_tr_b16 v[66:67], v141 offset:3936
    ds_read_b64_tr_b16 v[76:77], v141 offset:1984
    ds_read_b64_tr_b16 v[86:87], v141 offset:32
    ds_read_b32 v15, v142 offset:4384
    s_lshl_b32 s56, s44, 2
    s_lshr_b32 s55, s46, 1
    s_add_u32 s56, s56, s55
    s_mul_i32 s56, s56, 139264
    s_mul_i32 s55, s45, 5120
    s_add_u32 s56, s56, s55
    s_and_b32 s54, s46, 1
    s_lshl_b32 s55, s54, 11
    s_add_u32 s55, s55, s56
    s_lshl_b32 s54, s54, 9
    s_add_u32 s56, s56, s54
    s_add_u32 s56, s56, 4096
    v_cndmask_b32 v89, v97, v89, s[40:41]
    v_cndmask_b32 v90, v98, v90, s[42:43]
    v_cndmask_b32 v91, v99, v91, s[36:37]
    s_lshr_b32 s54, s46, 2
    s_or_b32 s54, s54, s44
    s_cbranch_scc1 Q_NOMASK
    v_mov_b32 v10, 0xce6e6b28
    s_mov_b32 s24, 0x11
    s_mov_b32 s25, 0x11
    s_mov_b32 s26, 0x33
    s_mov_b32 s27, 0x33
    s_mov_b32 s28, 0x77
    s_mov_b32 s29, 0x77
    s_mov_b32 s30, 0xf
    s_mov_b32 s31, 0xf
    v_cndmask_b32 v89, v89, v10, s[24:25]
    v_cndmask_b32 v90, v90, v10, s[26:27]
    v_cndmask_b32 v91, v91, v10, s[28:29]
    v_cndmask_b32 v92, v92, v10, s[30:31]
    v_cndmask_b32 v93, v93, v10, s[30:31]
    v_cndmask_b32 v94, v94, v10, s[30:31]
    v_cndmask_b32 v95, v95, v10, s[30:31]
Q_NOMASK:
    v_max3_f32 v10, v88, v89, v90
    v_max3_f32 v11, v91, v92, v93
    v_max3_f32 v10, v10, v94, v95
    v_max_f32 v10, v10, v11
    v_mul_f32 v10, s62, v10
    v_pk_fma_f32 v[88:89], v[88:89], s[62:63], v[10:11] op_sel_hi:[1,1,0] neg_lo:[0,0,1] neg_hi:[0,0,1]
    v_pk_fma_f32 v[90:91], v[90:91], s[62:63], v[10:11] op_sel_hi:[1,1,0] neg_lo:[0,0,1] neg_hi:[0,0,1]
    v_pk_fma_f32 v[92:93], v[92:93], s[62:63], v[10:11] op_sel_hi:[1,1,0] neg_lo:[0,0,1] neg_hi:[0,0,1]
    v_pk_fma_f32 v[94:95], v[94:95], s[62:63], v[10:11] op_sel_hi:[1,1,0] neg_lo:[0,0,1] neg_hi:[0,0,1]
    v_exp_f32 v88, v88
    v_exp_f32 v89, v89
    v_exp_f32 v90, v90
    v_exp_f32 v91, v91
    v_exp_f32 v92, v92
    v_exp_f32 v93, v93
    v_exp_f32 v94, v94
    v_exp_f32 v95, v95
    v_pk_add_f32 v[10:11], v[88:89], v[90:91]
    v_pk_add_f32 v[12:13], v[92:93], v[94:95]
    v_pk_add_f32 v[10:11], v[10:11], v[12:13]
    v_add_f32 v10, v10, v11
    v_rcp_f32 v10, v10
    s_waitcnt lgkmcnt(0)
    v_mul_f32 v10, v10, v15
    v_pk_mul_f32 v[88:89], v[88:89], v[10:11] op_sel_hi:[1,0]
    v_pk_mul_f32 v[90:91], v[90:91], v[10:11] op_sel_hi:[1,0]
    v_pk_mul_f32 v[92:93], v[92:93], v[10:11] op_sel_hi:[1,0]
    v_pk_mul_f32 v[94:95], v[94:95], v[10:11] op_sel_hi:[1,0]
    v_cvt_pk_bf16_f32 v12, v88, v89
    v_cvt_pk_bf16_f32 v13, v90, v91
    v_cvt_pk_bf16_f32 v122, v92, v93
    v_cvt_pk_bf16_f32 v123, v94, v95
    v_and_b32 v120, v12, v144
    v_and_b32 v121, v13, v145
    v_xor_b32 v124, v12, v120
    v_xor_b32 v125, v13, v121
    v_mfma_f32_4x4x4_16b_bf16 v[100:103], v[68:69], v[122:123], 0
    v_mfma_f32_4x4x4_16b_bf16 v[104:107], v[70:71], v[122:123], 0
    v_mfma_f32_4x4x4_16b_bf16 v[108:111], v[72:73], v[122:123], 0
    v_mfma_f32_4x4x4_16b_bf16 v[112:115], v[74:75], v[122:123], 0
    v_mfma_f32_4x4x4_16b_bf16 v[116:119], v[76:77], v[122:123], 0
    v_mfma_f32_4x4x4_16b_bf16 v[100:103], v[58:59], v[120:121], v[100:103]
    v_mfma_f32_4x4x4_16b_bf16 v[104:107], v[60:61], v[120:121], v[104:107]
    v_mfma_f32_4x4x4_16b_bf16 v[108:111], v[62:63], v[120:121], v[108:111]
    v_mfma_f32_4x4x4_16b_bf16 v[112:115], v[64:65], v[120:121], v[112:115]
    v_mfma_f32_4x4x4_16b_bf16 v[116:119], v[66:67], v[120:121], v[116:119]
    v_mfma_f32_4x4x4_16b_bf16 v[100:103], v[78:79], v[124:125], v[100:103]
    v_mfma_f32_4x4x4_16b_bf16 v[104:107], v[80:81], v[124:125], v[104:107]
    v_mfma_f32_4x4x4_16b_bf16 v[108:111], v[82:83], v[124:125], v[108:111]
    v_mfma_f32_4x4x4_16b_bf16 v[112:115], v[84:85], v[124:125], v[112:115]
    v_mfma_f32_4x4x4_16b_bf16 v[116:119], v[86:87], v[124:125], v[116:119]
    s_nop 0
    v_cvt_pk_bf16_f32 v16, v100, v101
    v_cvt_pk_bf16_f32 v17, v102, v103
    v_cvt_pk_bf16_f32 v18, v104, v105
    v_cvt_pk_bf16_f32 v19, v106, v107
    buffer_store_dwordx4 v[16:19], v143, s[32:35], s55 offen sc1
    v_cvt_pk_bf16_f32 v24, v116, v117
    v_cvt_pk_bf16_f32 v25, v118, v119
    v_cvt_pk_bf16_f32 v20, v108, v109
    v_cvt_pk_bf16_f32 v21, v110, v111
    v_cvt_pk_bf16_f32 v22, v112, v113
    v_cvt_pk_bf16_f32 v23, v114, v115
    buffer_store_dwordx4 v[20:23], v143, s[32:35], s55 offen offset:512 sc1
    v_permlane32_swap_b32 v24, v26
    v_permlane32_swap_b32 v25, v27
    s_mov_b32 exec_hi, 0
    buffer_store_dwordx4 v[24:27], v146, s[32:35], s56 offen sc1
    s_mov_b32 exec_hi, -1
    buffer_load_dwordx4 v[252:255], v153, s[32:35], s76 offen offset:0 sc1
    s_add_u32 s76, s76, 5120
    s_lshl_b32 s61, s44, 5
    s_add_u32 s61, s61, s45
    s_add_u32 s61, s61, 8
    s_mul_i32 s58, s46, 20480
    s_mov_b32 s68, s72
    s_and_b32 s69, s73, 0xffff
    s_mov_b32 s70, 2621440
    s_mov_b32 s71, 0x00020000
    v_lshrrev_b32 v9, 4, v0
    v_and_b32 v1, 15, v0
    v_lshlrev_b32 v4, 9, v9
    v_lshl_add_u32 v4, v1, 4, v4
    v_add_u32 v5, 139264, v4
    v_add_u32 v6, s58, v152
    v_add_u32 v7, 139264, v152
    v_and_b32 v10, 1, v9
    v_lshlrev_b32 v10, 7, v10
    v_xor_b32 v144, v10, v6
    v_xor_b32 v145, 64, v144
    v_lshlrev_b32 v10, 6, v9
    v_xor_b32 v146, v10, v6
    v_lshrrev_b32 v10, 3, v0
    s_and_b32 s54, s46, 1
    s_lshl_b32 s54, s54, 3
    v_add_u32 v10, s54, v10
    v_bfe_u32 v11, v0, 1, 2
    v_and_b32 v12, 1, v0
    v_and_b32 v13, 3, v0
    v_lshlrev_b32 v13, 2, v13
    v_xor_b32 v13, v13, v10
    v_lshlrev_b32 v13, 4, v13
    v_lshl_add_u32 v13, v11, 8, v13
    v_mul_u32_u24 v14, 3072, v12
    s_lshr_b32 s55, s46, 1
    s_mul_i32 s56, s55, 5120
    v_add3_u32 v147, v13, v14, s56
    v_lshlrev_b32 v13, 2, v11
    v_xor_b32 v13, v13, v10
    v_lshlrev_b32 v13, 4, v13
    v_lshl_add_u32 v13, v11, 8, v13
    v_lshl_add_u32 v13, v12, 3, v13
    s_add_u32 s56, s56, 2048
    v_add_u32 v148, s56, v13
    v_mul_u32_u24 v13, 2560, v10
    v_mul_u32_u24 v14, 40, v11
    v_add_u32 v13, v13, v14
    v_mul_u32_u24 v14, 24, v12
    v_add_u32 v149, v13, v14
    v_lshl_add_u32 v150, v12, 2, v13
    v_lshlrev_b32 v151, 2, v10
    s_bfe_u32 s57, s81, 0x40000
    s_lshl_b32 s57, s57, 11
    s_add_u32 s36, s80, s57
    s_bfe_u32 s57, s81, 0x40004
    s_lshl_b32 s57, s57, 11
    s_add_u32 s37, s80, s57
    s_bfe_u32 s57, s81, 0x40008
    s_lshl_b32 s57, s57, 11
    s_add_u32 s38, s80, s57
    s_bfe_u32 s57, s81, 0x4000c
    s_lshl_b32 s57, s57, 11
    s_add_u32 s39, s80, s57
    s_bfe_u32 s57, s81, 0x40010
    s_lshl_b32 s57, s57, 11
    s_add_u32 s40, s80, s57
    s_bfe_u32 s57, s81, 0x40014
    s_lshl_b32 s57, s57, 11
    s_add_u32 s41, s80, s57
    s_bfe_u32 s57, s81, 0x40018
    s_lshl_b32 s57, s57, 11
    s_add_u32 s42, s80, s57
    s_bfe_u32 s57, s81, 0x4001c
    s_lshl_b32 s57, s57, 11
    s_add_u32 s43, s80, s57
    s_add_u32 s24, s80, 16384
    s_mov_b32 s28, s20
    s_and_b32 s29, s21, 0xffff
    s_mov_b32 s30, 12607488
    s_mov_b32 s31, 0x00020000
    s_cmp_ge_u32 s46, 4
    s_cselect_b32 s30, 0, s30
    s_lshr_b32 s54, s46, 1
    s_lshl_b32 s25, s22, 2
    s_add_u32 s25, s25, s54
    s_lshl_b32 s25, s25, 6
    s_add_u32 s25, s25, 12582912
    s_lshl_b32 s26, s22, 6
    s_and_b32 s57, s54, 1
    s_lshl_b32 s57, s57, 5
    s_add_u32 s26, s26, s57
    s_lshr_b32 s57, s54, 1
    s_add_u32 s26, s26, s57
    s_mul_i32 s26, s26, 1280
    s_mul_i32 s57, s23, 160
    s_add_u32 s26, s26, s57
    s_waitcnt vmcnt(1)
    s_branch P2_ENTRY
Q_SIDE:
    s_cmp_eq_u32 s47, 2
    s_cbranch_scc1 Q_RELAY0
    s_cmp_eq_u32 s47, 1
    s_cbranch_scc1 Q_UNITS
    s_cmp_lg_u32 s46, 3
    s_cbranch_scc1 Q_BACK
    s_cmp_eq_u32 s47, 3
    s_cbranch_scc1 Q_FLAG
    s_cmp_eq_u32 s47, 7
    s_cbranch_scc1 Q_FLD
    s_branch Q_BACK
Q_UNITS:
    s_mul_i32 s54, s61, 205
    s_lshr_b32 s54, s54, 10
    s_mul_i32 s55, s54, 5
    s_sub_u32 s55, s61, s55
    s_mul_i32 s54, s54, 80
    s_mul_i32 s56, s55, 20
    s_cmp_eq_u32 s55, 4
    s_cselect_b32 s56, 16, s56
    s_cselect_b32 s57, 20480, 0
    s_add_u32 s54, s54, s56
    s_sub_u32 s55, s61, 40
    s_lshl_b32 s55, s55, 4
    s_cmp_lt_u32 s61, 40
    s_cselect_b32 s54, s54, s55
    s_cselect_b32 s57, s57, 0
    s_cselect_b32 s40, s8, s16
    s_cselect_b32 s55, s9, s17
    s_mov_b32 s42, 819200
    s_cselect_b32 s42, s42, 1966080
    s_and_b32 s41, s55, 0xffff
    s_mov_b32 s43, 0x00020000
    s_mul_i32 s54, s54, 1280
    s_add_u32 s55, s46, 0
    s_mul_i32 s56, s55, 205
    s_lshr_b32 s56, s56, 10
    s_mul_i32 s56, s56, s57
    s_lshl_b32 s55, s55, 10
    s_add_u32 m0, s55, 122112
    s_add_u32 s56, s56, s55
    s_add_u32 s56, s56, s54
    buffer_load_dwordx4 v152, s[40:43], s56 offen nt lds
    s_add_u32 s55, s46, 8
    s_mul_i32 s56, s55, 205
    s_lshr_b32 s56, s56, 10
    s_mul_i32 s56, s56, s57
    s_lshl_b32 s55, s55, 10
    s_add_u32 m0, s55, 122112
    s_add_u32 s56, s56, s55
    s_add_u32 s56, s56, s54
    buffer_load_dwordx4 v152, s[40:43], s56 offen nt lds
    s_cmp_ge_u32 s46, 4
    s_cbranch_scc1 Q_U1
    s_add_u32 s55, s46, 16
    s_mul_i32 s56, s55, 205
    s_lshr_b32 s56, s56, 10
    s_mul_i32 s56, s56, s57
    s_lshl_b32 s55, s55, 10
    s_add_u32 m0, s55, 122112
    s_add_u32 s56, s56, s55
    s_add_u32 s56, s56, s54
    buffer_load_dwordx4 v152, s[40:43], s56 offen nt lds
Q_U1:
    s_cmp_ge_u32 s61, 8
    s_cbranch_scc1 Q_BACK
    s_mov_b32 s40, s16
    s_and_b32 s41, s17, 0xffff
    s_mov_b32 s42, 1966080
    s_mov_b32 s43, 0x00020000
    s_add_u32 s54, s61, 88
    s_mul_i32 s54, s54, 20480
    s_lshl_b32 s55, s46, 10
    s_add_u32 s54, s54, s55
    s_add_u32 m0, s55, 142592
    s_add_u32 s56, s54, 8192
    buffer_load_dwordx4 v152, s[40:43], s54 offen nt lds
    s_add_u32 m0, s55, 150784
    s_cmp_ge_u32 s46, 4
    buffer_load_dwordx4 v152, s[40:43], s56 offen nt lds
    s_cbranch_scc1 Q_BACK
    s_add_u32 m0, s55, 158976
    s_add_u32 s56, s54, 16384
    buffer_load_dwordx4 v152, s[40:43], s56 offen nt lds
    s_branch Q_BACK
Q_RELAY0:
    s_cmp_eq_u32 s46, 3
    s_cbranch_scc0 Q_R0
    buffer_load_dword v154, off, s[64:67], 0 sc1
Q_R0:
    v_bfe_u32 v156, v0, 4, 1
    v_bfe_u32 v157, v0, 2, 2
    v_lshl_add_u32 v157, v156, 3, v157
    v_mul_u32_u24 v157, 1280, v157
    v_and_b32 v158, 3, v0
    v_mul_u32_u24 v158, 40, v158
    s_mul_i32 s56, s46, 160
    s_add_u32 s56, s56, 122112
    v_add3_u32 v157, v157, v158, s56
    v_lshl_add_u32 v158, v3, 3, v157
    v_lshlrev_b32 v159, 4, v1
    v_lshl_add_u32 v156, v3, 10, v159
    s_mov_b32 s54, s61
    ds_read_b64_tr_b16 v[160:161], v158 offset:0
    ds_read_b64_tr_b16 v[162:163], v158 offset:5120
    ds_read_b64_tr_b16 v[164:165], v158 offset:16
    ds_read_b64_tr_b16 v[166:167], v158 offset:5136
    ds_read_b64_tr_b16 v[168:169], v157 offset:32
    ds_read_b64_tr_b16 v[170:171], v157 offset:5152
    s_mul_i32 s56, s46, 68
    s_lshr_b32 s57, s54, 1
    s_add_u32 s56, s56, s57
    s_mul_i32 s56, s56, 5120
    s_and_b32 s57, s54, 1
    s_lshl_b32 s57, s57, 9
    s_add_u32 s56, s56, s57
    s_add_u32 s56, s56, 9437184
    s_add_u32 s57, s56, 4096
    s_waitcnt lgkmcnt(0)
    buffer_store_dwordx4 v[160:163], v156, s[32:35], s56 offen sc1
    buffer_store_dwordx4 v[164:167], v156, s[32:35], s56 offen offset:2048 sc1
    s_mov_b64 exec, 0xffffffff
    buffer_store_dwordx4 v[168:171], v159, s[32:35], s57 offen sc1
    s_mov_b64 exec, -1
    s_cmp_ge_u32 s61, 8
    s_cbranch_scc1 Q_BACK
    s_add_u32 s54, s61, 128
    ds_read_b64_tr_b16 v[172:173], v158 offset:20480
    ds_read_b64_tr_b16 v[174:175], v158 offset:25600
    ds_read_b64_tr_b16 v[176:177], v158 offset:20496
    ds_read_b64_tr_b16 v[178:179], v158 offset:25616
    ds_read_b64_tr_b16 v[180:181], v157 offset:20512
    ds_read_b64_tr_b16 v[182:183], v157 offset:25632
    s_mul_i32 s56, s46, 68
    s_lshr_b32 s57, s54, 1
    s_add_u32 s56, s56, s57
    s_mul_i32 s56, s56, 5120
    s_and_b32 s57, s54, 1
    s_lshl_b32 s57, s57, 9
    s_add_u32 s56, s56, s57
    s_add_u32 s56, s56, 9437184
    s_add_u32 s57, s56, 4096
    s_waitcnt lgkmcnt(0)
    buffer_store_dwordx4 v[172:175], v156, s[32:35], s56 offen sc1
    buffer_store_dwordx4 v[176:179], v156, s[32:35], s56 offen offset:2048 sc1
    s_mov_b64 exec, 0xffffffff
    buffer_store_dwordx4 v[180:183], v159, s[32:35], s57 offen sc1
    s_mov_b64 exec, -1
    s_branch Q_BACK
Q_FLAG:
    s_mov_b32 s55, 20000
Q_NCHK:
    v_readfirstlane_b32 s10, v154
    s_nop 1
    s_cmp_lg_u32 s10, 0
    s_cbranch_scc1 Q_NOK
    s_sub_u32 s55, s55, 1
    s_cmp_eq_u32 s55, 0
    s_cbranch_scc1 Q_NOK
    s_sleep 8
    buffer_load_dword v154, off, s[64:67], 0 sc1
    s_waitcnt vmcnt(0)
    s_branch Q_NCHK
Q_NOK:
    s_lshl_b32 s54, s61, 2
    s_add_u32 s54, s54, 12603392
    s_mov_b64 exec, 1
    buffer_store_dword v154, off, s[32:35], s54 sc1
    s_mov_b64 exec, -1
    s_branch Q_BACK
Q_FLD:
    v_lshlrev_b32 v154, 3, v0
    s_mov_b32 s54, 12603392
    buffer_load_dwordx2 v[156:157], v154, s[32:35], s54 offen sc1
    s_branch Q_BACK
P2_ENTRY:
    s_barrier
    s_cmp_lg_u32 s46, 3
    s_cbranch_scc1 P2_NOFLAG
    v_mov_b32 v3, s10
    s_lshl_b32 s54, s61, 2
    s_add_u32 s54, s54, 12599296
    s_mov_b64 exec, 1
    buffer_store_dword v3, off, s[32:35], s54 sc1
    s_mov_b64 exec, -1
P2_NOFLAG:
    s_mul_i32 s58, s46, 20480
    s_add_u32 m0, s58, 0
    s_nop 0
    buffer_load_dwordx4 v152, s[32:35], s76 offen offset:0 sc1 lds
    buffer_load_dwordx4 v152, s[32:35], s76 offen offset:1024 sc1 lds
    buffer_load_dwordx4 v152, s[32:35], s76 offen offset:2048 sc1 lds
    buffer_load_dwordx4 v152, s[32:35], s76 offen offset:3072 sc1 lds
    s_add_u32 m0, s58, 4096
    s_nop 0
    buffer_load_dwordx4 v153, s[32:35], s76 offen sc1 lds
    s_add_u32 s76, s76, 5120
    s_add_u32 m0, s58, 5120
    s_nop 0
    buffer_load_dwordx4 v152, s[32:35], s76 offen offset:0 sc1 lds
    buffer_load_dwordx4 v152, s[32:35], s76 offen offset:1024 sc1 lds
    buffer_load_dwordx4 v152, s[32:35], s76 offen offset:2048 sc1 lds
    buffer_load_dwordx4 v152, s[32:35], s76 offen offset:3072 sc1 lds
    s_add_u32 m0, s58, 9216
    s_nop 0
    buffer_load_dwordx4 v153, s[32:35], s76 offen sc1 lds
    s_add_u32 s76, s76, 5120
    s_add_u32 m0, s58, 10240
    s_nop 0
    buffer_load_dwordx4 v152, s[32:35], s76 offen offset:0 sc1 lds
    buffer_load_dwordx4 v152, s[32:35], s76 offen offset:1024 sc1 lds
    buffer_load_dwordx4 v152, s[32:35], s76 offen offset:2048 sc1 lds
    buffer_load_dwordx4 v152, s[32:35], s76 offen offset:3072 sc1 lds
    s_add_u32 m0, s58, 14336
    s_nop 0
    buffer_load_dwordx4 v153, s[32:35], s76 offen sc1 lds
    s_add_u32 s76, s76, 5120
    s_cmp_ge_u32 s46, 4
    s_cbranch_scc1 P2_NOD
    s_add_u32 m0, s58, 15360
    s_nop 0
    buffer_load_dwordx4 v152, s[32:35], s76 offen offset:0 sc1 lds
    buffer_load_dwordx4 v152, s[32:35], s76 offen offset:1024 sc1 lds
    buffer_load_dwordx4 v152, s[32:35], s76 offen offset:2048 sc1 lds
    buffer_load_dwordx4 v152, s[32:35], s76 offen offset:3072 sc1 lds
    s_add_u32 m0, s58, 19456
    s_nop 0
    buffer_load_dwordx4 v153, s[32:35], s76 offen sc1 lds
    s_add_u32 s76, s76, 5120
P2_NOD:
    s_cmp_lg_u32 s46, 3
    s_cbranch_scc1 P2_GO
    s_lshr_b32 s54, s22, 1
    s_lshl_b32 s54, s54, 7
    s_add_u32 s54, s54, 12599296
    v_lshlrev_b32 v10, 2, v1
    s_mov_b32 s55, 100000
P2_POLL:
    buffer_load_dword v11, v10, s[32:35], s54 offen sc1
    s_waitcnt vmcnt(0)
    v_cmp_ne_u32 vcc, s10, v11
    s_nop 1
    s_cmp_eq_u64 vcc, 0
    s_cbranch_scc1 P2_GO
    s_sub_u32 s55, s55, 1
    s_cmp_lg_u32 s55, 0
    s_sleep 1
    s_cbranch_scc1 P2_POLL
P2_GO:
    s_barrier
    buffer_load_dwordx4 v[96:99], v4, s[32:35], s36 offen offset:0 sc1
    buffer_load_dwordx4 v[100:103], v4, s[32:35], s36 offen offset:256 sc1
    buffer_load_dwordx4 v[104:107], v5, s[32:35], s36 offen offset:0 sc1
    buffer_load_dwordx4 v[108:111], v5, s[32:35], s36 offen offset:256 sc1
    buffer_load_dword v8, v151, s[32:35], s25 offen sc1
    s_setprio 3
    s_waitcnt vmcnt(4)
    v_mfma_f32_16x16x32_bf16 v[16:19], v[156:159], v[96:99], 0
    v_mfma_f32_16x16x32_bf16 v[20:23], v[160:163], v[96:99], 0
    buffer_load_dwordx4 v[112:115], v4, s[32:35], s37 offen offset:0 sc1
    v_mfma_f32_16x16x32_bf16 v[24:27], v[164:167], v[96:99], 0
    v_mfma_f32_16x16x32_bf16 v[28:31], v[168:171], v[96:99], 0
    buffer_load_dwordx4 v[116:119], v4, s[32:35], s37 offen offset:256 sc1
    v_mfma_f32_16x16x32_bf16 v[32:35], v[172:175], v[96:99], 0
    s_waitcnt vmcnt(5)
    v_mfma_f32_16x16x32_bf16 v[36:39], v[156:159], v[100:103], 0
    v_mfma_f32_16x16x32_bf16 v[40:43], v[160:163], v[100:103], 0
    buffer_load_dwordx4 v[120:123], v5, s[32:35], s37 offen offset:0 sc1
    v_mfma_f32_16x16x32_bf16 v[44:47], v[164:167], v[100:103], 0
    v_mfma_f32_16x16x32_bf16 v[48:51], v[168:171], v[100:103], 0
    buffer_load_dwordx4 v[124:127], v5, s[32:35], s37 offen offset:256 sc1
    v_mfma_f32_16x16x32_bf16 v[52:55], v[172:175], v[100:103], 0
    s_waitcnt vmcnt(6)
    v_mfma_f32_16x16x32_bf16 v[56:59], v[156:159], v[104:107], 0
    v_mfma_f32_16x16x32_bf16 v[60:63], v[160:163], v[104:107], 0
    buffer_load_dwordx4 v[128:131], v4, s[32:35], s38 offen offset:0 sc1
    v_mfma_f32_16x16x32_bf16 v[64:67], v[164:167], v[104:107], 0
    v_mfma_f32_16x16x32_bf16 v[68:71], v[168:171], v[104:107], 0
    v_mfma_f32_16x16x32_bf16 v[72:75], v[172:175], v[104:107], 0
    s_setprio 2
    s_waitcnt vmcnt(6)
    v_mfma_f32_16x16x32_bf16 v[76:79], v[156:159], v[108:111], 0
    v_mfma_f32_16x16x32_bf16 v[80:83], v[160:163], v[108:111], 0
    buffer_load_dwordx4 v[132:135], v4, s[32:35], s38 offen offset:256 sc1
    v_mfma_f32_16x16x32_bf16 v[84:87], v[164:167], v[108:111], 0
    v_mfma_f32_16x16x32_bf16 v[88:91], v[168:171], v[108:111], 0
    v_mfma_f32_16x16x32_bf16 v[92:95], v[172:175], v[108:111], 0
    s_waitcnt vmcnt(5)
    v_mfma_f32_16x16x32_bf16 v[16:19], v[176:179], v[112:115], v[16:19]
    v_mfma_f32_16x16x32_bf16 v[20:23], v[180:183], v[112:115], v[20:23]
    buffer_load_dwordx4 v[136:139], v5, s[32:35], s38 offen offset:0 sc1
    v_mfma_f32_16x16x32_bf16 v[24:27], v[184:187], v[112:115], v[24:27]
    v_mfma_f32_16x16x32_bf16 v[28:31], v[188:191], v[112:115], v[28:31]
    v_mfma_f32_16x16x32_bf16 v[32:35], v[192:195], v[112:115], v[32:35]
    s_waitcnt vmcnt(5)
    v_mfma_f32_16x16x32_bf16 v[36:39], v[176:179], v[116:119], v[36:39]
    ds_read_b128 v[156:159], v6 offset:0
    v_mfma_f32_16x16x32_bf16 v[40:43], v[180:183], v[116:119], v[40:43]
    buffer_load_dwordx4 v[140:143], v5, s[32:35], s38 offen offset:256 sc1
    v_mfma_f32_16x16x32_bf16 v[44:47], v[184:187], v[116:119], v[44:47]
    ds_read_b128 v[160:163], v6 offset:1024
    v_mfma_f32_16x16x32_bf16 v[48:51], v[188:191], v[116:119], v[48:51]
    v_mfma_f32_16x16x32_bf16 v[52:55], v[192:195], v[116:119], v[52:55]
    ds_read_b128 v[164:167], v6 offset:2048
    s_setprio 1
    s_waitcnt vmcnt(5)
    v_mfma_f32_16x16x32_bf16 v[56:59], v[176:179], v[120:123], v[56:59]
    ds_read_b128 v[168:171], v6 offset:3072
    v_mfma_f32_16x16x32_bf16 v[60:63], v[180:183], v[120:123], v[60:63]
    buffer_load_dwordx4 v[96:99], v4, s[32:35], s39 offen offset:0 sc1
    v_mfma_f32_16x16x32_bf16 v[64:67], v[184:187], v[120:123], v[64:67]
    ds_read_b128 v[172:175], v6 offset:4096
    v_mfma_f32_16x16x32_bf16 v[68:71], v[188:191], v[120:123], v[68:71]
    v_mfma_f32_16x16x32_bf16 v[72:75], v[192:195], v[120:123], v[72:75]
    s_waitcnt vmcnt(5)
    v_mfma_f32_16x16x32_bf16 v[76:79], v[176:179], v[124:127], v[76:79]
    v_mfma_f32_16x16x32_bf16 v[80:83], v[180:183], v[124:127], v[80:83]
    buffer_load_dwordx4 v[100:103], v4, s[32:35], s39 offen offset:256 sc1
    v_mfma_f32_16x16x32_bf16 v[84:87], v[184:187], v[124:127], v[84:87]
    v_mfma_f32_16x16x32_bf16 v[88:91], v[188:191], v[124:127], v[88:91]
    v_mfma_f32_16x16x32_bf16 v[92:95], v[192:195], v[124:127], v[92:95]
    s_waitcnt vmcnt(5)
    v_mfma_f32_16x16x32_bf16 v[16:19], v[196:199], v[128:131], v[16:19]
    v_mfma_f32_16x16x32_bf16 v[20:23], v[200:203], v[128:131], v[20:23]
    buffer_load_dwordx4 v[104:107], v5, s[32:35], s39 offen offset:0 sc1
    v_mfma_f32_16x16x32_bf16 v[24:27], v[204:207], v[128:131], v[24:27]
    v_mfma_f32_16x16x32_bf16 v[28:31], v[208:211], v[128:131], v[28:31]
    v_mfma_f32_16x16x32_bf16 v[32:35], v[212:215], v[128:131], v[32:35]
    s_setprio 0
    s_waitcnt vmcnt(5)
    v_mfma_f32_16x16x32_bf16 v[36:39], v[196:199], v[132:135], v[36:39]
    ds_read_b128 v[176:179], v6 offset:5120
    v_mfma_f32_16x16x32_bf16 v[40:43], v[200:203], v[132:135], v[40:43]
    buffer_load_dwordx4 v[108:111], v5, s[32:35], s39 offen offset:256 sc1
    v_mfma_f32_16x16x32_bf16 v[44:47], v[204:207], v[132:135], v[44:47]
    ds_read_b128 v[180:183], v6 offset:6144
    v_mfma_f32_16x16x32_bf16 v[48:51], v[208:211], v[132:135], v[48:51]
    v_mfma_f32_16x16x32_bf16 v[52:55], v[212:215], v[132:135], v[52:55]
    ds_read_b128 v[184:187], v6 offset:7168
    s_waitcnt vmcnt(5)
    v_mfma_f32_16x16x32_bf16 v[56:59], v[196:199], v[136:139], v[56:59]
    ds_read_b128 v[188:191], v6 offset:8192
    v_mfma_f32_16x16x32_bf16 v[60:63], v[200:203], v[136:139], v[60:63]
    buffer_load_dwordx4 v[112:115], v4, s[32:35], s40 offen offset:0 sc1
    v_mfma_f32_16x16x32_bf16 v[64:67], v[204:207], v[136:139], v[64:67]
    ds_read_b128 v[192:195], v6 offset:9216
    v_mfma_f32_16x16x32_bf16 v[68:71], v[208:211], v[136:139], v[68:71]
    v_mfma_f32_16x16x32_bf16 v[72:75], v[212:215], v[136:139], v[72:75]
    s_waitcnt vmcnt(5)
    v_mfma_f32_16x16x32_bf16 v[76:79], v[196:199], v[140:143], v[76:79]
    v_mfma_f32_16x16x32_bf16 v[80:83], v[200:203], v[140:143], v[80:83]
    buffer_load_dwordx4 v[116:119], v4, s[32:35], s40 offen offset:256 sc1
    v_mfma_f32_16x16x32_bf16 v[84:87], v[204:207], v[140:143], v[84:87]
    v_mfma_f32_16x16x32_bf16 v[88:91], v[208:211], v[140:143], v[88:91]
    v_mfma_f32_16x16x32_bf16 v[92:95], v[212:215], v[140:143], v[92:95]
    s_setprio 3
    s_waitcnt vmcnt(5)
    v_mfma_f32_16x16x32_bf16 v[16:19], v[216:219], v[96:99], v[16:19]
    v_mfma_f32_16x16x32_bf16 v[20:23], v[220:223], v[96:99], v[20:23]
    buffer_load_dwordx4 v[120:123], v5, s[32:35], s40 offen offset:0 sc1
    v_mfma_f32_16x16x32_bf16 v[24:27], v[224:227], v[96:99], v[24:27]
    v_mfma_f32_16x16x32_bf16 v[28:31], v[228:231], v[96:99], v[28:31]
    v_mfma_f32_16x16x32_bf16 v[32:35], v[232:235], v[96:99], v[32:35]
    s_waitcnt vmcnt(5)
    v_mfma_f32_16x16x32_bf16 v[36:39], v[216:219], v[100:103], v[36:39]
    ds_read_b128 v[196:199], v6 offset:10240
    v_mfma_f32_16x16x32_bf16 v[40:43], v[220:223], v[100:103], v[40:43]
    buffer_load_dwordx4 v[124:127], v5, s[32:35], s40 offen offset:256 sc1
    v_mfma_f32_16x16x32_bf16 v[44:47], v[224:227], v[100:103], v[44:47]
    ds_read_b128 v[200:203], v6 offset:11264
    v_mfma_f32_16x16x32_bf16 v[48:51], v[228:231], v[100:103], v[48:51]
    v_mfma_f32_16x16x32_bf16 v[52:55], v[232:235], v[100:103], v[52:55]
    ds_read_b128 v[204:207], v6 offset:12288
    s_waitcnt vmcnt(5)
    v_mfma_f32_16x16x32_bf16 v[56:59], v[216:219], v[104:107], v[56:59]
    ds_read_b128 v[208:211], v6 offset:13312
    v_mfma_f32_16x16x32_bf16 v[60:63], v[220:223], v[104:107], v[60:63]
    buffer_load_dwordx4 v[128:131], v4, s[32:35], s41 offen offset:0 sc1
    v_mfma_f32_16x16x32_bf16 v[64:67], v[224:227], v[104:107], v[64:67]
    ds_read_b128 v[212:215], v6 offset:14336
    v_mfma_f32_16x16x32_bf16 v[68:71], v[228:231], v[104:107], v[68:71]
    v_mfma_f32_16x16x32_bf16 v[72:75], v[232:235], v[104:107], v[72:75]
    s_setprio 2
    s_waitcnt vmcnt(5)
    v_mfma_f32_16x16x32_bf16 v[76:79], v[216:219], v[108:111], v[76:79]
    v_mfma_f32_16x16x32_bf16 v[80:83], v[220:223], v[108:111], v[80:83]
    buffer_load_dwordx4 v[132:135], v4, s[32:35], s42 offen offset:0 sc1
    v_mfma_f32_16x16x32_bf16 v[84:87], v[224:227], v[108:111], v[84:87]
    v_mfma_f32_16x16x32_bf16 v[88:91], v[228:231], v[108:111], v[88:91]
    v_mfma_f32_16x16x32_bf16 v[92:95], v[232:235], v[108:111], v[92:95]
    s_waitcnt vmcnt(5)
    v_mfma_f32_16x16x32_bf16 v[16:19], v[236:239], v[112:115], v[16:19]
    v_mfma_f32_16x16x32_bf16 v[20:23], v[240:243], v[112:115], v[20:23]
    buffer_load_dwordx4 v[136:139], v4, s[32:35], s43 offen offset:0 sc1
    v_mfma_f32_16x16x32_bf16 v[24:27], v[244:247], v[112:115], v[24:27]
    v_mfma_f32_16x16x32_bf16 v[28:31], v[248:251], v[112:115], v[28:31]
    v_mfma_f32_16x16x32_bf16 v[32:35], v[252:255], v[112:115], v[32:35]
    s_waitcnt vmcnt(5)
    v_mfma_f32_16x16x32_bf16 v[36:39], v[236:239], v[116:119], v[36:39]
    ds_read_b128 v[216:219], v6 offset:15360
    v_mfma_f32_16x16x32_bf16 v[40:43], v[240:243], v[116:119], v[40:43]
    buffer_load_dwordx4 v[140:143], v4, s[28:31], s24 offen offset:0 sc1
    v_mfma_f32_16x16x32_bf16 v[44:47], v[244:247], v[116:119], v[44:47]
    ds_read_b128 v[220:223], v6 offset:16384
    v_mfma_f32_16x16x32_bf16 v[48:51], v[248:251], v[116:119], v[48:51]
    v_mfma_f32_16x16x32_bf16 v[52:55], v[252:255], v[116:119], v[52:55]
    ds_read_b128 v[224:227], v6 offset:17408
    s_setprio 1
    s_waitcnt vmcnt(5)
    v_mfma_f32_16x16x32_bf16 v[56:59], v[236:239], v[120:123], v[56:59]
    ds_read_b128 v[228:231], v6 offset:18432
    v_mfma_f32_16x16x32_bf16 v[60:63], v[240:243], v[120:123], v[60:63]
    buffer_load_dwordx4 v[96:99], v4, s[32:35], s41 offen offset:256 sc1
    v_mfma_f32_16x16x32_bf16 v[64:67], v[244:247], v[120:123], v[64:67]
    ds_read_b128 v[232:235], v6 offset:19456
    v_mfma_f32_16x16x32_bf16 v[68:71], v[248:251], v[120:123], v[68:71]
    v_mfma_f32_16x16x32_bf16 v[72:75], v[252:255], v[120:123], v[72:75]
    s_waitcnt vmcnt(5)
    v_mfma_f32_16x16x32_bf16 v[76:79], v[236:239], v[124:127], v[76:79]
    v_mfma_f32_16x16x32_bf16 v[80:83], v[240:243], v[124:127], v[80:83]
    buffer_load_dwordx4 v[100:103], v4, s[32:35], s42 offen offset:256 sc1
    v_mfma_f32_16x16x32_bf16 v[84:87], v[244:247], v[124:127], v[84:87]
    v_mfma_f32_16x16x32_bf16 v[88:91], v[248:251], v[124:127], v[88:91]
    v_mfma_f32_16x16x32_bf16 v[92:95], v[252:255], v[124:127], v[92:95]
    s_waitcnt vmcnt(5) lgkmcnt(0)
    v_mfma_f32_16x16x32_bf16 v[16:19], v[156:159], v[128:131], v[16:19]
    v_mfma_f32_16x16x32_bf16 v[20:23], v[160:163], v[128:131], v[20:23]
    buffer_load_dwordx4 v[104:107], v4, s[32:35], s43 offen offset:256 sc1
    v_mfma_f32_16x16x32_bf16 v[24:27], v[164:167], v[128:131], v[24:27]
    v_mfma_f32_16x16x32_bf16 v[28:31], v[168:171], v[128:131], v[28:31]
    v_mfma_f32_16x16x32_bf16 v[32:35], v[172:175], v[128:131], v[32:35]
    s_setprio 0
    s_waitcnt vmcnt(5)
    v_mfma_f32_16x16x32_bf16 v[16:19], v[176:179], v[132:135], v[16:19]
    v_mfma_f32_16x16x32_bf16 v[20:23], v[180:183], v[132:135], v[20:23]
    buffer_load_dwordx4 v[108:111], v4, s[28:31], s24 offen offset:256 sc1
    v_mfma_f32_16x16x32_bf16 v[24:27], v[184:187], v[132:135], v[24:27]
    v_mfma_f32_16x16x32_bf16 v[28:31], v[188:191], v[132:135], v[28:31]
    v_mfma_f32_16x16x32_bf16 v[32:35], v[192:195], v[132:135], v[32:35]
    s_waitcnt vmcnt(5)
    v_mfma_f32_16x16x32_bf16 v[16:19], v[196:199], v[136:139], v[16:19]
    v_mfma_f32_16x16x32_bf16 v[20:23], v[200:203], v[136:139], v[20:23]
    buffer_load_dwordx4 v[112:115], v5, s[32:35], s41 offen offset:0 sc1
    v_mfma_f32_16x16x32_bf16 v[24:27], v[204:207], v[136:139], v[24:27]
    v_mfma_f32_16x16x32_bf16 v[28:31], v[208:211], v[136:139], v[28:31]
    v_mfma_f32_16x16x32_bf16 v[32:35], v[212:215], v[136:139], v[32:35]
    s_waitcnt vmcnt(5)
    buffer_load_dwordx4 v[116:119], v5, s[32:35], s42 offen offset:0 sc1
    s_cmp_ge_u32 s46, 4
    s_cbranch_scc1 P2_SK0
    v_mfma_f32_16x16x32_bf16 v[16:19], v[216:219], v[140:143], v[16:19]
    v_mfma_f32_16x16x32_bf16 v[20:23], v[220:223], v[140:143], v[20:23]
    v_mfma_f32_16x16x32_bf16 v[24:27], v[224:227], v[140:143], v[24:27]
    v_mfma_f32_16x16x32_bf16 v[28:31], v[228:231], v[140:143], v[28:31]
    v_mfma_f32_16x16x32_bf16 v[32:35], v[232:235], v[140:143], v[32:35]
P2_SK0:
    s_setprio 3
    s_waitcnt vmcnt(5)
    v_mfma_f32_16x16x32_bf16 v[36:39], v[156:159], v[96:99], v[36:39]
    v_mfma_f32_16x16x32_bf16 v[40:43], v[160:163], v[96:99], v[40:43]
    buffer_load_dwordx4 v[120:123], v5, s[32:35], s43 offen offset:0 sc1
    v_mfma_f32_16x16x32_bf16 v[44:47], v[164:167], v[96:99], v[44:47]
    ds_write_b128 v144, v[16:19] offset:0
    v_mfma_f32_16x16x32_bf16 v[48:51], v[168:171], v[96:99], v[48:51]
    v_mfma_f32_16x16x32_bf16 v[52:55], v[172:175], v[96:99], v[52:55]
    ds_write_b128 v144, v[20:23] offset:1024
    s_waitcnt vmcnt(5)
    v_mfma_f32_16x16x32_bf16 v[36:39], v[176:179], v[100:103], v[36:39]
    v_mfma_f32_16x16x32_bf16 v[40:43], v[180:183], v[100:103], v[40:43]
    buffer_load_dwordx4 v[124:127], v5, s[28:31], s24 offen offset:0 sc1
    v_mfma_f32_16x16x32_bf16 v[44:47], v[184:187], v[100:103], v[44:47]
    ds_write_b128 v146, v[24:27] offset:2048
    v_mfma_f32_16x16x32_bf16 v[48:51], v[188:191], v[100:103], v[48:51]
    v_mfma_f32_16x16x32_bf16 v[52:55], v[192:195], v[100:103], v[52:55]
    ds_write_b128 v145, v[28:31] offset:3072
    s_waitcnt vmcnt(5)
    v_mfma_f32_16x16x32_bf16 v[36:39], v[196:199], v[104:107], v[36:39]
    v_mfma_f32_16x16x32_bf16 v[40:43], v[200:203], v[104:107], v[40:43]
    buffer_load_dwordx4 v[128:131], v5, s[32:35], s41 offen offset:256 sc1
    v_mfma_f32_16x16x32_bf16 v[44:47], v[204:207], v[104:107], v[44:47]
    ds_write_b128 v145, v[32:35] offset:4096
    v_mfma_f32_16x16x32_bf16 v[48:51], v[208:211], v[104:107], v[48:51]
    v_mfma_f32_16x16x32_bf16 v[52:55], v[212:215], v[104:107], v[52:55]
    s_setprio 2
    s_waitcnt vmcnt(5)
    buffer_load_dwordx4 v[132:135], v5, s[32:35], s42 offen offset:256 sc1
    s_cmp_ge_u32 s46, 4
    s_cbranch_scc1 P2_SK1
    v_mfma_f32_16x16x32_bf16 v[36:39], v[216:219], v[108:111], v[36:39]
    v_mfma_f32_16x16x32_bf16 v[40:43], v[220:223], v[108:111], v[40:43]
    v_mfma_f32_16x16x32_bf16 v[44:47], v[224:227], v[108:111], v[44:47]
    v_mfma_f32_16x16x32_bf16 v[48:51], v[228:231], v[108:111], v[48:51]
    v_mfma_f32_16x16x32_bf16 v[52:55], v[232:235], v[108:111], v[52:55]
P2_SK1:
    s_waitcnt vmcnt(5)
    v_mfma_f32_16x16x32_bf16 v[56:59], v[156:159], v[112:115], v[56:59]
    v_mfma_f32_16x16x32_bf16 v[60:63], v[160:163], v[112:115], v[60:63]
    buffer_load_dwordx4 v[136:139], v5, s[32:35], s43 offen offset:256 sc1
    v_mfma_f32_16x16x32_bf16 v[64:67], v[164:167], v[112:115], v[64:67]
    ds_write_b128 v144, v[36:39] offset:5120
    v_mfma_f32_16x16x32_bf16 v[68:71], v[168:171], v[112:115], v[68:71]
    v_mfma_f32_16x16x32_bf16 v[72:75], v[172:175], v[112:115], v[72:75]
    ds_write_b128 v144, v[40:43] offset:6144
    s_waitcnt vmcnt(5)
    v_mfma_f32_16x16x32_bf16 v[56:59], v[176:179], v[116:119], v[56:59]
    v_mfma_f32_16x16x32_bf16 v[60:63], v[180:183], v[116:119], v[60:63]
    buffer_load_dwordx4 v[140:143], v5, s[28:31], s24 offen offset:256 sc1
    v_mfma_f32_16x16x32_bf16 v[64:67], v[184:187], v[116:119], v[64:67]
    ds_write_b128 v146, v[44:47] offset:7168
    v_mfma_f32_16x16x32_bf16 v[68:71], v[188:191], v[116:119], v[68:71]
    v_mfma_f32_16x16x32_bf16 v[72:75], v[192:195], v[116:119], v[72:75]
    ds_write_b128 v145, v[48:51] offset:8192
    s_setprio 1
    s_waitcnt vmcnt(5)
    v_mfma_f32_16x16x32_bf16 v[56:59], v[196:199], v[120:123], v[56:59]
    v_mfma_f32_16x16x32_bf16 v[60:63], v[200:203], v[120:123], v[60:63]
    v_mfma_f32_16x16x32_bf16 v[64:67], v[204:207], v[120:123], v[64:67]
    ds_write_b128 v145, v[52:55] offset:9216
    v_mfma_f32_16x16x32_bf16 v[68:71], v[208:211], v[120:123], v[68:71]
    v_mfma_f32_16x16x32_bf16 v[72:75], v[212:215], v[120:123], v[72:75]
    s_waitcnt vmcnt(4)
    s_cmp_ge_u32 s46, 4
    s_cbranch_scc1 P2_SK2
    v_mfma_f32_16x16x32_bf16 v[56:59], v[216:219], v[124:127], v[56:59]
    v_mfma_f32_16x16x32_bf16 v[60:63], v[220:223], v[124:127], v[60:63]
    v_mfma_f32_16x16x32_bf16 v[64:67], v[224:227], v[124:127], v[64:67]
    v_mfma_f32_16x16x32_bf16 v[68:71], v[228:231], v[124:127], v[68:71]
    v_mfma_f32_16x16x32_bf16 v[72:75], v[232:235], v[124:127], v[72:75]
P2_SK2:
    s_waitcnt vmcnt(3)
    v_mfma_f32_16x16x32_bf16 v[76:79], v[156:159], v[128:131], v[76:79]
    v_mfma_f32_16x16x32_bf16 v[80:83], v[160:163], v[128:131], v[80:83]
    v_mfma_f32_16x16x32_bf16 v[84:87], v[164:167], v[128:131], v[84:87]
    ds_write_b128 v144, v[56:59] offset:10240
    v_mfma_f32_16x16x32_bf16 v[88:91], v[168:171], v[128:131], v[88:91]
    v_mfma_f32_16x16x32_bf16 v[92:95], v[172:175], v[128:131], v[92:95]
    ds_write_b128 v144, v[60:63] offset:11264
    s_setprio 0
    s_waitcnt vmcnt(2)
    v_mfma_f32_16x16x32_bf16 v[76:79], v[176:179], v[132:135], v[76:79]
    v_mfma_f32_16x16x32_bf16 v[80:83], v[180:183], v[132:135], v[80:83]
    v_mfma_f32_16x16x32_bf16 v[84:87], v[184:187], v[132:135], v[84:87]
    ds_write_b128 v146, v[64:67] offset:12288
    v_mfma_f32_16x16x32_bf16 v[88:91], v[188:191], v[132:135], v[88:91]
    v_mfma_f32_16x16x32_bf16 v[92:95], v[192:195], v[132:135], v[92:95]
    ds_write_b128 v145, v[68:71] offset:13312
    s_waitcnt vmcnt(1)
    v_mfma_f32_16x16x32_bf16 v[76:79], v[196:199], v[136:139], v[76:79]
    v_mfma_f32_16x16x32_bf16 v[80:83], v[200:203], v[136:139], v[80:83]
    v_mfma_f32_16x16x32_bf16 v[84:87], v[204:207], v[136:139], v[84:87]
    ds_write_b128 v145, v[72:75] offset:14336
    v_mfma_f32_16x16x32_bf16 v[88:91], v[208:211], v[136:139], v[88:91]
    v_mfma_f32_16x16x32_bf16 v[92:95], v[212:215], v[136:139], v[92:95]
    s_waitcnt vmcnt(0)
    s_cmp_ge_u32 s46, 4
    s_cbranch_scc1 P2_SK3
    v_mfma_f32_16x16x32_bf16 v[76:79], v[216:219], v[140:143], v[76:79]
    v_mfma_f32_16x16x32_bf16 v[80:83], v[220:223], v[140:143], v[80:83]
    v_mfma_f32_16x16x32_bf16 v[84:87], v[224:227], v[140:143], v[84:87]
    v_mfma_f32_16x16x32_bf16 v[88:91], v[228:231], v[140:143], v[88:91]
    v_mfma_f32_16x16x32_bf16 v[92:95], v[232:235], v[140:143], v[92:95]
P2_SK3:
    s_nop 7
    ds_write_b128 v144, v[76:79] offset:15360
    ds_write_b128 v144, v[80:83] offset:16384
    ds_write_b128 v146, v[84:87] offset:17408
    ds_write_b128 v145, v[88:91] offset:18432
    ds_write_b128 v145, v[92:95] offset:19456
    s_mov_b32 s55, s26
    v_add_u32 v10, 61440, v147
    v_add_u32 v11, 61440, v148
    v_add_u32 v12, 122880, v147
    v_add_u32 v13, 122880, v148
    s_waitcnt vmcnt(0) lgkmcnt(0)
    s_barrier
    ds_read_b128 v[156:159], v147 offset:0
    ds_read_b128 v[160:163], v147 offset:1024
    ds_read_b64 v[164:165], v148 offset:0
    ds_read_b128 v[166:169], v147 offset:20480
    ds_read_b128 v[170:173], v147 offset:21504
    ds_read_b64 v[174:175], v148 offset:20480
    ds_read_b128 v[176:179], v147 offset:40960
    ds_read_b128 v[180:183], v147 offset:41984
    ds_read_b64 v[184:185], v148 offset:40960
    ds_read_b128 v[186:189], v10 offset:0
    ds_read_b128 v[190:193], v10 offset:1024
    ds_read_b64 v[194:195], v11 offset:0
    ds_read_b128 v[196:199], v10 offset:20480
    ds_read_b128 v[200:203], v10 offset:21504
    ds_read_b64 v[204:205], v11 offset:20480
    s_waitcnt lgkmcnt(9)
    v_pk_add_f32 v[156:157], v[156:157], v[166:167]
    v_pk_add_f32 v[158:159], v[158:159], v[168:169]
    v_pk_add_f32 v[160:161], v[160:161], v[170:171]
    v_pk_add_f32 v[162:163], v[162:163], v[172:173]
    v_pk_add_f32 v[164:165], v[164:165], v[174:175]
    ds_read_b128 v[206:209], v10 offset:40960
    ds_read_b128 v[210:213], v10 offset:41984
    ds_read_b64 v[214:215], v11 offset:40960
    ds_read_b128 v[216:219], v12 offset:0
    ds_read_b128 v[220:223], v12 offset:1024
    ds_read_b64 v[224:225], v13 offset:0
    s_waitcnt lgkmcnt(9)
    v_pk_add_f32 v[176:177], v[176:177], v[186:187]
    v_pk_add_f32 v[178:179], v[178:179], v[188:189]
    v_pk_add_f32 v[180:181], v[180:181], v[190:191]
    v_pk_add_f32 v[182:183], v[182:183], v[192:193]
    v_pk_add_f32 v[184:185], v[184:185], v[194:195]
    ds_read_b128 v[226:229], v12 offset:20480
    ds_read_b128 v[230:233], v12 offset:21504
    ds_read_b64 v[234:235], v13 offset:20480
    s_waitcnt lgkmcnt(9)
    v_pk_add_f32 v[156:157], v[156:157], v[196:197]
    v_pk_add_f32 v[158:159], v[158:159], v[198:199]
    v_pk_add_f32 v[160:161], v[160:161], v[200:201]
    v_pk_add_f32 v[162:163], v[162:163], v[202:203]
    v_pk_add_f32 v[164:165], v[164:165], v[204:205]
    s_waitcnt lgkmcnt(6)
    v_pk_add_f32 v[176:177], v[176:177], v[206:207]
    v_pk_add_f32 v[178:179], v[178:179], v[208:209]
    v_pk_add_f32 v[180:181], v[180:181], v[210:211]
    v_pk_add_f32 v[182:183], v[182:183], v[212:213]
    v_pk_add_f32 v[184:185], v[184:185], v[214:215]
    s_waitcnt lgkmcnt(3)
    v_pk_add_f32 v[156:157], v[156:157], v[216:217]
    v_pk_add_f32 v[158:159], v[158:159], v[218:219]
    v_pk_add_f32 v[160:161], v[160:161], v[220:221]
    v_pk_add_f32 v[162:163], v[162:163], v[222:223]
    v_pk_add_f32 v[164:165], v[164:165], v[224:225]
    s_waitcnt lgkmcnt(0)
    v_pk_add_f32 v[176:177], v[176:177], v[226:227]
    v_pk_add_f32 v[178:179], v[178:179], v[228:229]
    v_pk_add_f32 v[180:181], v[180:181], v[230:231]
    v_pk_add_f32 v[182:183], v[182:183], v[232:233]
    v_pk_add_f32 v[184:185], v[184:185], v[234:235]
    v_pk_add_f32 v[156:157], v[156:157], v[176:177]
    v_pk_add_f32 v[158:159], v[158:159], v[178:179]
    v_pk_add_f32 v[160:161], v[160:161], v[180:181]
    v_pk_add_f32 v[162:163], v[162:163], v[182:183]
    v_pk_add_f32 v[164:165], v[164:165], v[184:185]
    v_pk_mul_f32 v[156:157], v[156:157], v[8:9] op_sel_hi:[1,0]
    v_pk_mul_f32 v[158:159], v[158:159], v[8:9] op_sel_hi:[1,0]
    v_pk_mul_f32 v[160:161], v[160:161], v[8:9] op_sel_hi:[1,0]
    v_pk_mul_f32 v[162:163], v[162:163], v[8:9] op_sel_hi:[1,0]
    v_pk_mul_f32 v[164:165], v[164:165], v[8:9] op_sel_hi:[1,0]
    v_cvt_pk_bf16_f32 v166, v156, v157
    v_cvt_pk_bf16_f32 v167, v158, v159
    v_cvt_pk_bf16_f32 v168, v160, v161
    v_cvt_pk_bf16_f32 v169, v162, v163
    v_cvt_pk_bf16_f32 v170, v164, v165
    buffer_store_dwordx4 v[166:169], v149, s[68:71], s55 offen
    buffer_store_dword v170, v150, s[68:71], s55 offen offset:16
K_END:
    s_endpgm
.section .rodata,"a"
.p2align 6
.amdhsa_kernel gated_mix__sliding_local_dilated__swiglu_ffn__prompt_kernel
  .amdhsa_next_free_vgpr 256
  .amdhsa_next_free_sgpr 102
  .amdhsa_accum_offset 256
  .amdhsa_group_segment_fixed_size 0
  .amdhsa_kernarg_size 88
  .amdhsa_user_sgpr_count 2
  .amdhsa_user_sgpr_kernarg_segment_ptr 1
  .amdhsa_system_sgpr_workgroup_id_x 1
.end_amdhsa_kernel
```
